```python
import torch

def _softmax(x, axis=-1):
    return torch.softmax(x, dim=axis)

def _gelu(x):
    return torch.nn.functional.gelu(x, approximate='tanh')

def _silu(x):
    return torch.nn.functional.silu(x)

def _sigmoid(x):
    return torch.sigmoid(x)

def _layernorm(x, axis=-1, eps=1e-05):
    m = x.mean(dim=axis, keepdim=True)
    v = x.var(dim=axis, keepdim=True, unbiased=False)
    return (x - m) / torch.sqrt(v + eps)

def _scatter_add(tgt, idx, src, axis=0):
    return tgt.clone().index_add_(axis, idx, src)

def _segment_sum(src, seg, n):
    out = torch.zeros((n,) + src.shape[1:], dtype=src.dtype)
    return out.index_add_(0, seg, src)

def _pad(x, pw):
    flat = tuple((v for pair in reversed(pw) for v in pair))
    return torch.nn.functional.pad(x, flat)
kernel_name = 'adaLN_cond__gqa_block_cached__swiglu_ffn__decode'

def setup_inputs():

    _w = lambda a: (lambda t: t.to(torch.bfloat16) if t.is_floating_point() else t)(torch.as_tensor(a))

    def _A_setup():
        B, Sq, D = (4, 1, 512)
        Hq, Hkv, Sk, Dh = (32, 8, 4096, 128)
        assert Hq % Hkv == 0, (Hq, Hkv)
        return {'x': _w((lambda *s: torch.randn(*s, dtype=torch.bfloat16) * 0.05)(B, Sq, D)), 'k_cache': _w((lambda *s: torch.randn(*s, dtype=torch.bfloat16) * 3.2)(B, Hkv, Sk, Dh)), 'v_cache': _w((lambda *s: torch.randn(*s, dtype=torch.bfloat16) * 0.4)(B, Hkv, Sk, Dh)), 'wq': _w((lambda *s: torch.randn(*s, dtype=torch.bfloat16) * 3.2)(D, Hq * Dh) * D ** (-0.5)), 'wo': _w((lambda *s: torch.randn(*s, dtype=torch.bfloat16) * 0.4)(Hq * Dh, D) * (Hq * Dh) ** (-0.5))}
    _A_in = _A_setup()

    def _B_setup():
        B, S, D, F = (4, 1, 512, 1792)
        return {'x': _w((lambda *s: torch.randn(*s, dtype=torch.bfloat16) * 0.05)(B, S, D)), 'w_gate': _w((lambda *s: torch.randn(*s, dtype=torch.bfloat16) * 0.05)(D, F)), 'w_up': _w((lambda *s: torch.randn(*s, dtype=torch.bfloat16) * 0.05)(D, F)), 'w_down': _w((lambda *s: torch.randn(*s, dtype=torch.bfloat16) * 0.05)(F, D))}
    _B_in = _B_setup()
    return {'A_x': _A_in['x'], 'A_k_cache': _A_in['k_cache'], 'A_v_cache': _A_in['v_cache'], 'A_wq': _A_in['wq'], 'A_wo': _A_in['wo'], 'B_x': _B_in['x'], 'B_w_gate': _B_in['w_gate'], 'B_w_up': _B_in['w_up'], 'B_w_down': _B_in['w_down'], 'c': _w((lambda *s: torch.randn(*s, dtype=torch.bfloat16) * 0.2)(4, 512) * 8.0), 'w_mod': _w((lambda *s: torch.randn(*s, dtype=torch.bfloat16) * 0.2)(512, 6 * 512) * 512 ** (-0.5) * 8.0)}

def reference(A_x, A_k_cache, A_v_cache, A_wq, A_wo, B_x, B_w_gate, B_w_up, B_w_down, c, w_mod):

    def _A_ref(x, k_cache, v_cache, wq, wo):
        B, Sq, D = x.shape
        Hq, Dh = (32, 128)
        Hkv = k_cache.shape[1]
        rep = Hq // Hkv
        q = (lambda x, *d: x.permute(*d))((x @ wq).reshape(B, Sq, Hq, Dh), 0, 2, 1, 3)
        k = (lambda x, n, axis: torch.repeat_interleave(x, n, dim=axis))(k_cache, rep, axis=1)
        v = (lambda x, n, axis: torch.repeat_interleave(x, n, dim=axis))(v_cache, rep, axis=1)
        scores = torch.einsum('bhqd,bhkd->bhqk', q, k) * Dh ** (-0.5)
        p = _softmax(scores, axis=-1)
        o = torch.einsum('bhqk,bhkd->bhqd', p, v)
        return (lambda x, *d: x.permute(*d))(o, 0, 2, 1, 3).reshape(B, Sq, Hq * Dh) @ wo

    def _B_ref(x, w_gate, w_up, w_down):
        g = _silu(x @ w_gate)
        u = x @ w_up
        return g * u @ w_down
    x = A_x
    mod = (_silu(c) @ w_mod).reshape(c.shape[0], 6, 1, -1)
    sa, ca, ga, sb, cb, gb = (mod[:, 0].clone(), mod[:, 1].clone(), mod[:, 2].clone(), mod[:, 3].clone(), mod[:, 4].clone(), mod[:, 5].clone())
    h = _layernorm(x, axis=-1) * (1 + ca) + sa
    x = x + ga * _A_ref(h, A_k_cache, A_v_cache, A_wq, A_wo)
    h = _layernorm(x, axis=-1) * (1 + cb) + sb
    x = x + gb * _B_ref(h, B_w_gate, B_w_up, B_w_down)
    return x
```

```asm
; @launch grid=(256,1,1) block=(768,1,1) lds=49152
.amdgcn_target "amdgcn-amd-amdhsa--gfx950"
.text
.globl adaLN_cond__gqa_block_cached__swiglu_ffn__decode_kernel
.p2align 8
.type adaLN_cond__gqa_block_cached__swiglu_ffn__decode_kernel,@function
adaLN_cond__gqa_block_cached__swiglu_ffn__decode_kernel:
s_cmp_ge_u32 s2, 256
s_cbranch_scc1 L_end
s_load_dwordx16 s[64:79], s[0:1], 0
s_load_dwordx8 s[80:87], s[0:1], 64
s_load_dwordx2 s[88:89], s[0:1], 104
v_lshrrev_b32 v1, 6, v0
v_and_b32 v0, 63, v0
s_mov_b32 s60, 0xaaaaaaaa
s_mov_b32 s61, 0xaaaaaaaa
v_readfirstlane_b32 s52, v1
s_mov_b32 s62, 0xcccccccc
s_mov_b32 s63, 0xcccccccc
s_mov_b32 s91, 0xffff0000
s_waitcnt lgkmcnt(0)
s_load_dword s59, s[88:89], 0
s_mov_b32 s12, s88
s_mov_b32 s13, s89
s_mov_b32 s14, 4194304
s_mov_b32 s15, 0x00020000
s_cmp_ge_u32 s52, 4
s_cbranch_scc1 L_kv
s_and_b32 s95, s2, 7
s_lshl_b32 s95, s95, 5
s_and_b32 s57, s2, 0x18
s_or_b32 s95, s95, s57
s_lshr_b32 s57, s2, 5
s_or_b32 s95, s95, s57
s_setprio 3
s_mov_b32 s16, s70
s_mov_b32 s17, s71
s_mov_b32 s18, 4194304
s_mov_b32 s19, 0x00020000
s_mov_b32 s20, s72
s_mov_b32 s21, s73
s_mov_b32 s22, 4194304
s_mov_b32 s23, 0x00020000
s_mov_b32 s24, s84
s_mov_b32 s25, s85
s_mov_b32 s26, 3145728
s_mov_b32 s27, 0x00020000
s_mov_b32 s28, s76
s_mov_b32 s29, s77
s_mov_b32 s30, 1835008
s_mov_b32 s31, 0x00020000
s_mov_b32 s32, s78
s_mov_b32 s33, s79
s_mov_b32 s34, 1835008
s_mov_b32 s35, 0x00020000
s_mov_b32 s36, s80
s_mov_b32 s37, s81
s_mov_b32 s38, 1835008
s_mov_b32 s39, 0x00020000
s_mov_b32 s40, s64
s_mov_b32 s41, s65
s_mov_b32 s42, 4096
s_mov_b32 s43, 0x00020000
s_mov_b32 s44, s82
s_mov_b32 s45, s83
s_mov_b32 s46, 4096
s_mov_b32 s47, 0x00020000
s_mov_b32 s48, s86
s_mov_b32 s49, s87
s_mov_b32 s50, 4096
s_mov_b32 s51, 0x00020000
v_lshrrev_b32 v5, 4, v0
v_bfe_u32 v6, v0, 2, 2
v_and_b32 v7, 3, v0
v_and_b32 v14, 15, v0
v_lshlrev_b32 v14, 4, v14
v_lshlrev_b32 v15, 4, v0
v_mov_b32 v10, 0
v_lshlrev_b32 v11, 2, v0
s_cmp_lg_u32 s52, 0
s_cbranch_scc1 L_s_nz
s_mov_b64 exec, 0xffff
ds_write_b32 v11, v10 offset:41344
s_mov_b64 exec, -1
L_s_nz:
s_cmp_ge_u32 s2, 128
s_cbranch_scc1 L_s_nf
s_and_b32 s96, s2, 7
s_lshl_b32 s96, s96, 6
s_cmp_ge_u32 s2, 64
s_cbranch_scc1 L_s_nof1a
s_lshl_b32 s57, s52, 4
s_add_u32 s57, s57, s96
v_lshlrev_b32 v10, 10, v6
v_lshl_add_u32 v10, v5, 3, v10
s_lshl_b32 s58, s57, 1
buffer_load_dwordx2 v[16:17], v10, s[44:47], s58 offen
v_mul_u32_u24 v10, 24576, v5
v_add_u32 v10, v10, v14
s_mul_i32 s57, s57, 6144
s_lshr_b32 s58, s2, 3
s_lshl_b32 s58, s58, 8
s_add_u32 s57, s57, s58
buffer_load_dwordx4 v[72:75], v10, s[24:27], s57 offen nt
s_add_u32 s57, s57, 6144
buffer_load_dwordx4 v[76:79], v10, s[24:27], s57 offen nt
s_add_u32 s57, s57, 6144
buffer_load_dwordx4 v[80:83], v10, s[24:27], s57 offen nt
s_add_u32 s57, s57, 6144
buffer_load_dwordx4 v[84:87], v10, s[24:27], s57 offen nt
L_s_nof1a:
v_lshlrev_b32 v10, 10, v6
v_lshl_add_u32 v10, v5, 8, v10
v_lshl_add_u32 v10, v7, 6, v10
buffer_load_dwordx4 v[104:107], v10, s[40:43], 0 offen offset:0
buffer_load_dwordx4 v[108:111], v10, s[40:43], 0 offen offset:16
buffer_load_dwordx4 v[112:115], v10, s[40:43], 0 offen offset:32
buffer_load_dwordx4 v[116:119], v10, s[40:43], 0 offen offset:48
s_lshr_b32 s57, s52, 1
s_lshl_b32 s57, s57, 5
s_add_u32 s97, s96, s57
s_and_b32 s57, s52, 1
s_lshl_b32 s57, s57, 2
s_add_u32 s97, s97, s57
v_lshlrev_b32 v10, 10, v6
v_lshl_add_u32 v10, v5, 1, v10
s_lshl_b32 s57, s97, 1
buffer_load_ushort v20, v10, s[40:43], s57 offen offset:0
buffer_load_ushort v21, v10, s[40:43], s57 offen offset:16
buffer_load_ushort v22, v10, s[40:43], s57 offen offset:32
buffer_load_ushort v23, v10, s[40:43], s57 offen offset:48
v_lshl_add_u32 v10, v5, 13, v14
s_lshl_b32 s57, s97, 13
s_lshr_b32 s58, s2, 3
s_lshl_b32 s58, s58, 9
s_add_u32 s57, s57, s58
buffer_load_dwordx4 v[40:43], v10, s[16:19], s57 offen nt
buffer_load_dwordx4 v[56:59], v10, s[16:19], s57 offen offset:256 nt
s_add_u32 s57, s57, 65536
buffer_load_dwordx4 v[44:47], v10, s[16:19], s57 offen nt
buffer_load_dwordx4 v[60:63], v10, s[16:19], s57 offen offset:256 nt
s_add_u32 s57, s57, 65536
buffer_load_dwordx4 v[48:51], v10, s[16:19], s57 offen nt
buffer_load_dwordx4 v[64:67], v10, s[16:19], s57 offen offset:256 nt
s_add_u32 s57, s57, 65536
buffer_load_dwordx4 v[52:55], v10, s[16:19], s57 offen nt
buffer_load_dwordx4 v[68:71], v10, s[16:19], s57 offen offset:256 nt
s_waitcnt lgkmcnt(0)
s_barrier
v_mov_b32 v10, 0xffff
v_mov_b32 v2, s91
v_cndmask_b32 v2, v10, v2, s[60:61]
v_mov_b32 v10, 0
v_cndmask_b32 v3, v10, v2, s[62:63]
v_cndmask_b32 v2, v2, v10, s[62:63]
s_waitcnt lgkmcnt(0)
s_add_u32 s59, s59, 1
s_and_b32 s53, s59, 0xffff
s_and_b32 s94, s59, 15
v_mov_b32 v1, s53
s_cmp_ge_u32 s2, 64
s_cbranch_scc1 L_s_nof1b
s_waitcnt vmcnt(20)
v_lshlrev_b32 v24, 16, v16
v_and_b32 v25, s91, v16
v_lshlrev_b32 v26, 16, v17
v_and_b32 v27, s91, v17
v_mul_f32 v28, 0xbfb8aa3b, v24
v_mul_f32 v29, 0xbfb8aa3b, v25
v_mul_f32 v30, 0xbfb8aa3b, v26
v_mul_f32 v31, 0xbfb8aa3b, v27
v_exp_f32 v28, v28
v_exp_f32 v29, v29
v_exp_f32 v30, v30
v_exp_f32 v31, v31
s_nop 0
v_add_f32 v28, 1.0, v28
v_add_f32 v29, 1.0, v29
v_add_f32 v30, 1.0, v30
v_add_f32 v31, 1.0, v31
v_rcp_f32 v28, v28
v_rcp_f32 v29, v29
v_rcp_f32 v30, v30
v_rcp_f32 v31, v31
s_nop 0
v_mul_f32 v24, v24, v28
v_mul_f32 v25, v25, v29
v_mul_f32 v26, v26, v30
v_mul_f32 v27, v27, v31
v_cvt_pk_bf16_f32 v24, v24, v24
v_cvt_pk_bf16_f32 v25, v25, v25
v_cvt_pk_bf16_f32 v26, v26, v26
v_cvt_pk_bf16_f32 v27, v27, v27
v_and_b32 v28, v24, v2
v_and_b32 v29, v24, v3
v_and_b32 v30, v25, v2
v_and_b32 v31, v25, v3
v_and_b32 v32, v26, v2
v_and_b32 v33, v26, v3
v_and_b32 v34, v27, v2
v_and_b32 v35, v27, v3
s_nop 1
s_waitcnt vmcnt(16)
v_mfma_f32_16x16x16_bf16 v[88:91], v[72:73], v[28:29], 0
v_mfma_f32_16x16x16_bf16 v[92:95], v[74:75], v[28:29], 0
v_mfma_f32_16x16x16_bf16 v[88:91], v[76:77], v[30:31], v[88:91]
v_mfma_f32_16x16x16_bf16 v[92:95], v[78:79], v[30:31], v[92:95]
v_mfma_f32_16x16x16_bf16 v[88:91], v[80:81], v[32:33], v[88:91]
v_mfma_f32_16x16x16_bf16 v[92:95], v[82:83], v[32:33], v[92:95]
v_mfma_f32_16x16x16_bf16 v[88:91], v[84:85], v[34:35], v[88:91]
v_mfma_f32_16x16x16_bf16 v[92:95], v[86:87], v[34:35], v[92:95]
s_nop 7
s_lshl_b32 s57, s52, 11
v_add_u32 v10, s57, v15
ds_write_b128 v10, v[88:91] offset:24576
ds_write_b128 v10, v[92:95] offset:25600
s_waitcnt lgkmcnt(0)
v_mov_b32 v10, 41344
v_mov_b32 v11, 1
s_mov_b64 exec, 1
ds_add_u32 v10, v11
s_mov_b64 exec, -1
v_mov_b32 v10, 41344
s_mov_b32 s55, 0
L_lw_3:
ds_read_b32 v11, v10
s_waitcnt lgkmcnt(0)
v_readfirstlane_b32 s57, v11
s_add_u32 s55, s55, 1
s_cmp_ge_u32 s57, 4
s_cbranch_scc1 L_lwd_4
s_cmp_lt_u32 s55, 400000
s_cbranch_scc1 L_lw_3
L_lwd_4:
s_cmp_ge_u32 s52, 2
s_cbranch_scc1 L_crs_5
s_and_b32 s57, s52, 1
s_lshl_b32 s57, s57, 10
v_add_u32 v10, s57, v15
ds_read_b128 v[72:75], v10 offset:24576
ds_read_b128 v[76:79], v10 offset:26624
ds_read_b128 v[80:83], v10 offset:28672
ds_read_b128 v[84:87], v10 offset:30720
s_and_b32 s57, s2, 7
s_lshl_b32 s57, s57, 3
s_lshr_b32 s58, s2, 3
s_add_u32 s57, s57, s58
s_lshl_b32 s57, s57, 11
s_add_u32 s57, s57, 655360
s_waitcnt lgkmcnt(0)
v_add_f32 v72, v72, v76
v_add_f32 v80, v80, v84
v_add_f32 v73, v73, v77
v_add_f32 v81, v81, v85
v_add_f32 v74, v74, v78
v_add_f32 v82, v82, v86
v_add_f32 v75, v75, v79
v_add_f32 v83, v83, v87
v_add_f32 v72, v72, v80
v_add_f32 v73, v73, v81
v_add_f32 v74, v74, v82
v_add_f32 v75, v75, v83
v_and_or_b32 v72, v72, -16, s94
v_and_or_b32 v73, v73, -16, s94
v_and_or_b32 v74, v74, -16, s94
v_and_or_b32 v75, v75, -16, s94
buffer_store_dwordx4 v[72:75], v10, s[12:15], s57 offen sc1
L_crs_5:
L_s_nof1b:
s_waitcnt vmcnt(8)
v_lshlrev_b32 v120, 16, v104
v_and_b32 v121, s91, v104
v_lshlrev_b32 v122, 16, v105
v_and_b32 v123, s91, v105
v_lshlrev_b32 v124, 16, v106
v_and_b32 v125, s91, v106
v_lshlrev_b32 v126, 16, v107
v_and_b32 v127, s91, v107
v_lshlrev_b32 v128, 16, v108
v_and_b32 v129, s91, v108
v_lshlrev_b32 v130, 16, v109
v_and_b32 v131, s91, v109
v_lshlrev_b32 v132, 16, v110
v_and_b32 v133, s91, v110
v_lshlrev_b32 v134, 16, v111
v_and_b32 v135, s91, v111
v_lshlrev_b32 v136, 16, v112
v_and_b32 v137, s91, v112
v_lshlrev_b32 v138, 16, v113
v_and_b32 v139, s91, v113
v_lshlrev_b32 v140, 16, v114
v_and_b32 v141, s91, v114
v_lshlrev_b32 v142, 16, v115
v_and_b32 v143, s91, v115
v_lshlrev_b32 v144, 16, v116
v_and_b32 v145, s91, v116
v_lshlrev_b32 v146, 16, v117
v_and_b32 v147, s91, v117
v_lshlrev_b32 v148, 16, v118
v_and_b32 v149, s91, v118
v_lshlrev_b32 v150, 16, v119
v_and_b32 v151, s91, v119
v_add_f32 v16, v120, v121
v_add_f32 v10, v122, v123
v_add_f32 v16, v16, v124
v_add_f32 v10, v10, v125
v_add_f32 v16, v16, v126
v_add_f32 v10, v10, v127
v_add_f32 v16, v16, v128
v_add_f32 v10, v10, v129
v_add_f32 v16, v16, v130
v_add_f32 v10, v10, v131
v_add_f32 v16, v16, v132
v_add_f32 v10, v10, v133
v_add_f32 v16, v16, v134
v_add_f32 v10, v10, v135
v_add_f32 v16, v16, v136
v_add_f32 v10, v10, v137
v_add_f32 v16, v16, v138
v_add_f32 v10, v10, v139
v_add_f32 v16, v16, v140
v_add_f32 v10, v10, v141
v_add_f32 v16, v16, v142
v_add_f32 v10, v10, v143
v_add_f32 v16, v16, v144
v_add_f32 v10, v10, v145
v_add_f32 v16, v16, v146
v_add_f32 v10, v10, v147
v_add_f32 v16, v16, v148
v_add_f32 v10, v10, v149
v_add_f32 v16, v16, v150
v_add_f32 v10, v10, v151
v_add_f32 v16, v16, v10
s_nop 1
v_add_f32_dpp v16, v16, v16 quad_perm:[1,0,3,2] row_mask:0xf bank_mask:0xf
s_nop 1
v_add_f32_dpp v16, v16, v16 quad_perm:[2,3,0,1] row_mask:0xf bank_mask:0xf
v_mov_b32 v10, v16
s_nop 1
v_permlane16_swap_b32 v16, v10
v_add_f32 v16, v16, v10
v_mov_b32 v10, v16
s_nop 1
v_permlane32_swap_b32 v16, v10
v_add_f32 v16, v16, v10
v_mul_f32 v16, 0x3b000000, v16
v_sub_f32 v120, v120, v16
v_sub_f32 v121, v121, v16
v_sub_f32 v122, v122, v16
v_sub_f32 v123, v123, v16
v_sub_f32 v124, v124, v16
v_sub_f32 v125, v125, v16
v_sub_f32 v126, v126, v16
v_sub_f32 v127, v127, v16
v_sub_f32 v128, v128, v16
v_sub_f32 v129, v129, v16
v_sub_f32 v130, v130, v16
v_sub_f32 v131, v131, v16
v_sub_f32 v132, v132, v16
v_sub_f32 v133, v133, v16
v_sub_f32 v134, v134, v16
v_sub_f32 v135, v135, v16
v_sub_f32 v136, v136, v16
v_sub_f32 v137, v137, v16
v_sub_f32 v138, v138, v16
v_sub_f32 v139, v139, v16
v_sub_f32 v140, v140, v16
v_sub_f32 v141, v141, v16
v_sub_f32 v142, v142, v16
v_sub_f32 v143, v143, v16
v_sub_f32 v144, v144, v16
v_sub_f32 v145, v145, v16
v_sub_f32 v146, v146, v16
v_sub_f32 v147, v147, v16
v_sub_f32 v148, v148, v16
v_sub_f32 v149, v149, v16
v_sub_f32 v150, v150, v16
v_sub_f32 v151, v151, v16
v_mul_f32 v17, v120, v120
v_mul_f32 v10, v121, v121
v_fmac_f32 v17, v122, v122
v_fmac_f32 v10, v123, v123
v_fmac_f32 v17, v124, v124
v_fmac_f32 v10, v125, v125
v_fmac_f32 v17, v126, v126
v_fmac_f32 v10, v127, v127
v_fmac_f32 v17, v128, v128
v_fmac_f32 v10, v129, v129
v_fmac_f32 v17, v130, v130
v_fmac_f32 v10, v131, v131
v_fmac_f32 v17, v132, v132
v_fmac_f32 v10, v133, v133
v_fmac_f32 v17, v134, v134
v_fmac_f32 v10, v135, v135
v_fmac_f32 v17, v136, v136
v_fmac_f32 v10, v137, v137
v_fmac_f32 v17, v138, v138
v_fmac_f32 v10, v139, v139
v_fmac_f32 v17, v140, v140
v_fmac_f32 v10, v141, v141
v_fmac_f32 v17, v142, v142
v_fmac_f32 v10, v143, v143
v_fmac_f32 v17, v144, v144
v_fmac_f32 v10, v145, v145
v_fmac_f32 v17, v146, v146
v_fmac_f32 v10, v147, v147
v_fmac_f32 v17, v148, v148
v_fmac_f32 v10, v149, v149
v_fmac_f32 v17, v150, v150
v_fmac_f32 v10, v151, v151
v_add_f32 v17, v17, v10
s_nop 1
v_add_f32_dpp v17, v17, v17 quad_perm:[1,0,3,2] row_mask:0xf bank_mask:0xf
s_nop 1
v_add_f32_dpp v17, v17, v17 quad_perm:[2,3,0,1] row_mask:0xf bank_mask:0xf
v_mov_b32 v10, v17
s_nop 1
v_permlane16_swap_b32 v17, v10
v_add_f32 v17, v17, v10
v_mov_b32 v10, v17
s_nop 1
v_permlane32_swap_b32 v17, v10
v_add_f32 v17, v17, v10
v_mul_f32 v17, 0x3b000000, v17
v_cvt_pk_bf16_f32 v10, v16, v17
v_lshlrev_b32 v16, 16, v10
v_and_b32 v17, s91, v10
v_add_f32 v17, 0x3727c5ac, v17
v_cvt_pk_bf16_f32 v17, v17, v17
v_and_b32 v17, s91, v17
v_sqrt_f32 v17, v17
s_nop 0
v_cvt_pk_bf16_f32 v17, v17, v17
v_and_b32 v17, s91, v17
v_rcp_f32 v17, v17
s_nop 0
v_lshlrev_b32 v24, 16, v20
v_lshlrev_b32 v25, 16, v21
v_lshlrev_b32 v26, 16, v22
v_lshlrev_b32 v27, 16, v23
v_sub_f32 v24, v24, v16
v_sub_f32 v25, v25, v16
v_sub_f32 v26, v26, v16
v_sub_f32 v27, v27, v16
v_cvt_pk_bf16_f32 v10, v24, v25
v_lshlrev_b32 v24, 16, v10
v_and_b32 v25, s91, v10
v_cvt_pk_bf16_f32 v11, v26, v27
v_lshlrev_b32 v26, 16, v11
v_and_b32 v27, s91, v11
v_mul_f32 v24, v24, v17
v_mul_f32 v25, v25, v17
v_mul_f32 v26, v26, v17
v_mul_f32 v27, v27, v17
v_cvt_pk_bf16_f32 v10, v24, v25
v_lshlrev_b32 v24, 16, v10
v_and_b32 v25, s91, v10
v_cvt_pk_bf16_f32 v11, v26, v27
v_lshlrev_b32 v26, 16, v11
v_and_b32 v27, s91, v11
v_lshlrev_b32 v12, 14, v7
v_lshl_add_u32 v12, v6, 6, v12
v_lshl_add_u32 v12, v5, 4, v12
s_bfe_u32 s57, s2, 0x20001
s_lshl_b32 s54, s57, 11
s_and_b32 s57, s52, 1
s_lshl_b32 s57, s57, 10
s_add_u32 s54, s54, s57
s_and_b32 s57, s2, 1
s_lshl_b32 s57, s57, 1
s_lshr_b32 s58, s52, 1
s_add_u32 s57, s57, s58
s_lshl_b32 s57, s57, 8
s_add_u32 s54, s54, s57
s_add_u32 s54, s54, 655360
s_add_u32 s97, s54, 65536
s_add_u32 s98, s54, 8192
s_add_u32 s99, s54, 73728
s_mov_b32 s55, 0
L_poll_6:
buffer_load_dwordx4 v[72:75], v12, s[12:15], s54 offen sc1
buffer_load_dwordx4 v[76:79], v12, s[12:15], s97 offen sc1
buffer_load_dwordx4 v[80:83], v12, s[12:15], s98 offen sc1
buffer_load_dwordx4 v[84:87], v12, s[12:15], s99 offen sc1
s_waitcnt vmcnt(0)
v_bitop3_b32 v8, v72, v73, v74 bitop3:0x80
v_or3_b32 v9, v72, v73, v74
v_bitop3_b32 v8, v8, v75, v76 bitop3:0x80
v_or3_b32 v9, v9, v75, v76
v_bitop3_b32 v8, v8, v77, v78 bitop3:0x80
v_or3_b32 v9, v9, v77, v78
v_bitop3_b32 v8, v8, v79, v80 bitop3:0x80
v_or3_b32 v9, v9, v79, v80
v_bitop3_b32 v8, v8, v81, v82 bitop3:0x80
v_or3_b32 v9, v9, v81, v82
v_bitop3_b32 v8, v8, v83, v84 bitop3:0x80
v_or3_b32 v9, v9, v83, v84
v_bitop3_b32 v8, v8, v85, v86 bitop3:0x80
v_or3_b32 v9, v9, v85, v86
v_bitop3_b32 v8, v8, v87, v87 bitop3:0x80
v_or3_b32 v9, v9, v87, v87
v_xor_b32 v8, v8, v1
v_xor_b32 v9, v9, v1
v_or_b32 v8, v8, v9
v_and_b32 v8, 0xf, v8
v_cmp_ne_u32 vcc, 0, v8
s_add_u32 s55, s55, 1
s_cmp_lt_u32 s55, 4000
s_cbranch_scc0 L_pd_7
s_cbranch_vccnz L_poll_6
L_pd_7:
v_add_f32 v72, v72, v76
v_add_f32 v80, v80, v84
v_add_f32 v73, v73, v77
v_add_f32 v81, v81, v85
v_add_f32 v74, v74, v78
v_add_f32 v82, v82, v86
v_add_f32 v75, v75, v79
v_add_f32 v83, v83, v87
s_nop 0
v_add_f32_dpp v72, v72, v72 quad_perm:[1,0,3,2] row_mask:0xf bank_mask:0xf
v_add_f32_dpp v73, v73, v73 quad_perm:[1,0,3,2] row_mask:0xf bank_mask:0xf
v_add_f32_dpp v74, v74, v74 quad_perm:[1,0,3,2] row_mask:0xf bank_mask:0xf
v_add_f32_dpp v75, v75, v75 quad_perm:[1,0,3,2] row_mask:0xf bank_mask:0xf
v_add_f32_dpp v80, v80, v80 quad_perm:[1,0,3,2] row_mask:0xf bank_mask:0xf
v_add_f32_dpp v81, v81, v81 quad_perm:[1,0,3,2] row_mask:0xf bank_mask:0xf
v_add_f32_dpp v82, v82, v82 quad_perm:[1,0,3,2] row_mask:0xf bank_mask:0xf
v_add_f32_dpp v83, v83, v83 quad_perm:[1,0,3,2] row_mask:0xf bank_mask:0xf
v_add_f32_dpp v72, v72, v72 quad_perm:[2,3,0,1] row_mask:0xf bank_mask:0xf
v_add_f32_dpp v73, v73, v73 quad_perm:[2,3,0,1] row_mask:0xf bank_mask:0xf
v_add_f32_dpp v74, v74, v74 quad_perm:[2,3,0,1] row_mask:0xf bank_mask:0xf
v_add_f32_dpp v75, v75, v75 quad_perm:[2,3,0,1] row_mask:0xf bank_mask:0xf
v_add_f32_dpp v80, v80, v80 quad_perm:[2,3,0,1] row_mask:0xf bank_mask:0xf
v_add_f32_dpp v81, v81, v81 quad_perm:[2,3,0,1] row_mask:0xf bank_mask:0xf
v_add_f32_dpp v82, v82, v82 quad_perm:[2,3,0,1] row_mask:0xf bank_mask:0xf
v_add_f32_dpp v83, v83, v83 quad_perm:[2,3,0,1] row_mask:0xf bank_mask:0xf
v_cvt_pk_bf16_f32 v10, v72, v73
v_lshlrev_b32 v72, 16, v10
v_and_b32 v73, s91, v10
v_cvt_pk_bf16_f32 v11, v74, v75
v_lshlrev_b32 v74, 16, v11
v_and_b32 v75, s91, v11
v_cvt_pk_bf16_f32 v10, v80, v81
v_lshlrev_b32 v80, 16, v10
v_and_b32 v81, s91, v10
v_cvt_pk_bf16_f32 v11, v82, v83
v_lshlrev_b32 v82, 16, v11
v_and_b32 v83, s91, v11
v_add_f32 v80, 1.0, v80
v_add_f32 v81, 1.0, v81
v_add_f32 v82, 1.0, v82
v_add_f32 v83, 1.0, v83
v_cvt_pk_bf16_f32 v10, v80, v81
v_lshlrev_b32 v80, 16, v10
v_and_b32 v81, s91, v10
v_cvt_pk_bf16_f32 v11, v82, v83
v_lshlrev_b32 v82, 16, v11
v_and_b32 v83, s91, v11
v_mul_f32 v24, v24, v80
v_mul_f32 v25, v25, v81
v_mul_f32 v26, v26, v82
v_mul_f32 v27, v27, v83
v_cvt_pk_bf16_f32 v10, v24, v25
v_lshlrev_b32 v24, 16, v10
v_and_b32 v25, s91, v10
v_cvt_pk_bf16_f32 v11, v26, v27
v_lshlrev_b32 v26, 16, v11
v_and_b32 v27, s91, v11
v_add_f32 v24, v24, v72
v_add_f32 v25, v25, v73
v_add_f32 v26, v26, v74
v_add_f32 v27, v27, v75
v_cvt_pk_bf16_f32 v24, v24, v24
v_cvt_pk_bf16_f32 v25, v25, v25
v_cvt_pk_bf16_f32 v26, v26, v26
v_cvt_pk_bf16_f32 v27, v27, v27
v_and_b32 v28, v24, v2
v_and_b32 v29, v24, v3
v_and_b32 v30, v25, v2
v_and_b32 v31, v25, v3
v_and_b32 v32, v26, v2
v_and_b32 v33, v26, v3
v_and_b32 v34, v27, v2
v_and_b32 v35, v27, v3
s_nop 1
s_nop 1
v_mfma_f32_16x16x16_bf16 v[16:19], v[40:41], v[28:29], 0
v_mfma_f32_16x16x16_bf16 v[20:23], v[42:43], v[28:29], 0
v_mfma_f32_16x16x16_bf16 v[16:19], v[44:45], v[30:31], v[16:19]
v_mfma_f32_16x16x16_bf16 v[20:23], v[46:47], v[30:31], v[20:23]
v_mfma_f32_16x16x16_bf16 v[16:19], v[48:49], v[32:33], v[16:19]
v_mfma_f32_16x16x16_bf16 v[20:23], v[50:51], v[32:33], v[20:23]
v_mfma_f32_16x16x16_bf16 v[16:19], v[52:53], v[34:35], v[16:19]
v_mfma_f32_16x16x16_bf16 v[20:23], v[54:55], v[34:35], v[20:23]
v_mfma_f32_16x16x16_bf16 v[88:91], v[56:57], v[28:29], 0
v_mfma_f32_16x16x16_bf16 v[92:95], v[58:59], v[28:29], 0
v_mfma_f32_16x16x16_bf16 v[88:91], v[60:61], v[30:31], v[88:91]
v_mfma_f32_16x16x16_bf16 v[92:95], v[62:63], v[30:31], v[92:95]
v_mfma_f32_16x16x16_bf16 v[88:91], v[64:65], v[32:33], v[88:91]
v_mfma_f32_16x16x16_bf16 v[92:95], v[66:67], v[32:33], v[92:95]
v_mfma_f32_16x16x16_bf16 v[88:91], v[68:69], v[34:35], v[88:91]
v_mfma_f32_16x16x16_bf16 v[92:95], v[70:71], v[34:35], v[92:95]
s_nop 7
s_lshl_b32 s57, s52, 11
v_add_u32 v10, s57, v15
ds_write_b128 v10, v[16:19] offset:4096
ds_write_b128 v10, v[20:23] offset:5120
ds_write_b128 v10, v[88:91] offset:12288
ds_write_b128 v10, v[92:95] offset:13312
s_waitcnt lgkmcnt(0)
v_mov_b32 v10, 41348
v_mov_b32 v11, 1
s_mov_b64 exec, 1
ds_add_u32 v10, v11
s_mov_b64 exec, -1
v_mov_b32 v10, 41348
s_mov_b32 s55, 0
L_lw_10:
ds_read_b32 v11, v10
s_waitcnt lgkmcnt(0)
v_readfirstlane_b32 s57, v11
s_add_u32 s55, s55, 1
s_cmp_ge_u32 s57, 4
s_cbranch_scc1 L_lwd_11
s_cmp_lt_u32 s55, 400000
s_cbranch_scc1 L_lw_10
L_lwd_11:
s_and_b32 s57, s52, 1
s_lshl_b32 s57, s57, 10
v_add_u32 v10, s57, v15
s_lshr_b32 s57, s52, 1
s_lshl_b32 s57, s57, 13
v_add_u32 v11, s57, v10
ds_read_b128 v[96:99], v11 offset:4096
ds_read_b128 v[100:103], v11 offset:6144
ds_read_b128 v[104:107], v11 offset:8192
ds_read_b128 v[108:111], v11 offset:10240
s_and_b32 s57, s2, 7
s_lshl_b32 s57, s57, 5
s_lshr_b32 s58, s2, 3
s_lshl_b32 s58, s58, 1
s_add_u32 s57, s57, s58
s_lshr_b32 s58, s52, 1
s_add_u32 s57, s57, s58
s_lshl_b32 s57, s57, 11
s_add_u32 s57, s57, 65536
s_waitcnt lgkmcnt(0)
v_add_f32 v96, v96, v100
v_add_f32 v104, v104, v108
v_add_f32 v97, v97, v101
v_add_f32 v105, v105, v109
v_add_f32 v98, v98, v102
v_add_f32 v106, v106, v110
v_add_f32 v99, v99, v103
v_add_f32 v107, v107, v111
v_add_f32 v96, v96, v104
v_add_f32 v97, v97, v105
v_add_f32 v98, v98, v106
v_add_f32 v99, v99, v107
v_and_or_b32 v96, v96, -16, s94
v_and_or_b32 v97, v97, -16, s94
v_and_or_b32 v98, v98, -16, s94
v_and_or_b32 v99, v99, -16, s94
buffer_store_dwordx4 v[96:99], v10, s[12:15], s57 offen sc1
L_crs_12:
v_mov_b32 v10, 41360
v_mov_b32 v11, 1
s_mov_b64 exec, 1
ds_add_u32 v10, v11
s_mov_b64 exec, -1
s_branch L_s_join
L_s_nf:
s_waitcnt lgkmcnt(0)
s_barrier
s_waitcnt lgkmcnt(0)
s_add_u32 s59, s59, 1
s_and_b32 s53, s59, 0xffff
s_and_b32 s94, s59, 15
v_mov_b32 v1, s53
v_mov_b32 v10, 0xffff
v_mov_b32 v2, s91
v_cndmask_b32 v2, v10, v2, s[60:61]
v_mov_b32 v10, 0
v_cndmask_b32 v3, v10, v2, s[62:63]
v_cndmask_b32 v2, v2, v10, s[62:63]
v_mov_b32 v10, 0xffff
v_mov_b32 v4, s91
v_cndmask_b32 v4, v10, v4, s[60:61]
L_s_join:
v_lshrrev_b32 v12, 5, v0
v_lshlrev_b32 v12, 16, v12
v_bfe_u32 v13, v0, 4, 1
v_lshl_add_u32 v12, v13, 10, v12
v_lshl_add_u32 v12, v6, 8, v12
v_lshl_add_u32 v12, v7, 4, v12
s_bfe_u32 s57, s2, 0x20003
s_and_b32 s58, s2, 1
s_lshl_b32 s58, s58, 2
s_add_u32 s57, s57, s58
s_lshl_b32 s57, s57, 2
s_add_u32 s57, s57, s52
s_lshl_b32 s57, s57, 11
s_bfe_u32 s58, s2, 0x20001
s_lshl_b32 s58, s58, 6
s_add_u32 s57, s57, s58
s_add_u32 s54, s57, 65536
s_add_u32 s97, s54, 131072
s_add_u32 s98, s54, 262144
s_add_u32 s99, s54, 393216
s_mov_b32 s55, 0
L_poll_13:
buffer_load_dwordx4 v[16:19], v12, s[12:15], s54 offen sc1
buffer_load_dwordx4 v[20:23], v12, s[12:15], s97 offen sc1
buffer_load_dwordx4 v[24:27], v12, s[12:15], s98 offen sc1
buffer_load_dwordx4 v[28:31], v12, s[12:15], s99 offen sc1
s_waitcnt vmcnt(0)
v_bitop3_b32 v8, v16, v17, v18 bitop3:0x80
v_or3_b32 v9, v16, v17, v18
v_bitop3_b32 v8, v8, v19, v20 bitop3:0x80
v_or3_b32 v9, v9, v19, v20
v_bitop3_b32 v8, v8, v21, v22 bitop3:0x80
v_or3_b32 v9, v9, v21, v22
v_bitop3_b32 v8, v8, v23, v24 bitop3:0x80
v_or3_b32 v9, v9, v23, v24
v_bitop3_b32 v8, v8, v25, v26 bitop3:0x80
v_or3_b32 v9, v9, v25, v26
v_bitop3_b32 v8, v8, v27, v28 bitop3:0x80
v_or3_b32 v9, v9, v27, v28
v_bitop3_b32 v8, v8, v29, v30 bitop3:0x80
v_or3_b32 v9, v9, v29, v30
v_bitop3_b32 v8, v8, v31, v31 bitop3:0x80
v_or3_b32 v9, v9, v31, v31
v_xor_b32 v8, v8, v1
v_xor_b32 v9, v9, v1
v_or_b32 v8, v8, v9
v_and_b32 v8, 0xf, v8
v_cmp_ne_u32 vcc, 0, v8
s_add_u32 s55, s55, 1
s_cmp_lt_u32 s55, 4000
s_cbranch_scc0 L_pd_14
s_cbranch_vccnz L_poll_13
L_pd_14:
v_add_f32 v16, v16, v20
v_add_f32 v24, v24, v28
v_add_f32 v17, v17, v21
v_add_f32 v25, v25, v29
v_add_f32 v18, v18, v22
v_add_f32 v26, v26, v30
v_add_f32 v19, v19, v23
v_add_f32 v27, v27, v31
v_add_f32 v16, v16, v24
v_add_f32 v17, v17, v25
v_add_f32 v18, v18, v26
v_add_f32 v19, v19, v27
s_nop 1
v_permlane32_swap_b32 v16, v18
v_permlane32_swap_b32 v17, v19
v_add_f32 v16, v16, v18
v_add_f32 v17, v17, v19
v_cvt_pk_bf16_f32 v16, v16, v17
v_lshlrev_b32 v10, 6, v6
v_lshrrev_b32 v11, 5, v0
v_lshl_add_u32 v10, v11, 5, v10
v_lshl_add_u32 v10, v13, 3, v10
v_lshl_add_u32 v10, v7, 1, v10
s_lshl_b32 s57, s52, 8
v_add_u32 v10, s57, v10
ds_write_b16 v10, v16 offset:20480
ds_write_b16_d16_hi v10, v16 offset:20496
s_waitcnt lgkmcnt(0)
v_mov_b32 v10, 41352
v_mov_b32 v11, 1
s_mov_b64 exec, 1
ds_add_u32 v10, v11
s_mov_b64 exec, -1
s_lshr_b32 s57, s95, 3
s_lshl_b32 s101, s57, 7
s_bfe_u32 s57, s95, 0x10002
s_lshl_b32 s57, s57, 6
s_add_u32 s101, s101, s57
s_lshr_b32 s57, s52, 1
s_lshl_b32 s57, s57, 5
s_add_u32 s101, s101, s57
s_and_b32 s57, s52, 1
s_lshl_b32 s57, s57, 2
s_add_u32 s101, s101, s57
s_lshl_b32 s57, s101, 10
s_and_b32 s58, s95, 3
s_lshl_b32 s58, s58, 8
s_add_u32 s57, s57, s58
v_lshl_add_u32 v10, v5, 10, v14
buffer_load_dwordx4 v[56:59], v10, s[20:23], s57 offen nt
s_add_u32 s57, s57, 8192
buffer_load_dwordx4 v[60:63], v10, s[20:23], s57 offen nt
s_add_u32 s57, s57, 8192
buffer_load_dwordx4 v[64:67], v10, s[20:23], s57 offen nt
s_add_u32 s57, s57, 8192
buffer_load_dwordx4 v[68:71], v10, s[20:23], s57 offen nt
s_cmp_lt_u32 s2, 128
s_cbranch_scc1 L_s_prep_done
s_cmp_ge_u32 s2, 184
s_cbranch_scc1 L_s_nf1b
s_branch L_s_prep_done
L_s_nf1b:
s_cmp_ge_u32 s2, 248
s_cbranch_scc1 L_s_prep_done
s_sub_u32 s57, s2, 184
s_and_b32 s100, s57, 7
s_lshl_b32 s100, s100, 3
s_lshr_b32 s57, s57, 3
s_add_u32 s100, s100, s57
s_add_u32 s100, s100, 32
v_lshlrev_b32 v10, 10, v6
v_lshl_add_u32 v10, v5, 6, v10
v_lshl_add_u32 v10, v7, 4, v10
s_lshl_b32 s57, s52, 8
buffer_load_dwordx4 v[16:19], v10, s[44:47], s57 offen
v_mul_u32_u24 v10, 196608, v5
v_and_b32 v11, 15, v0
v_lshl_add_u32 v10, v11, 2, v10
s_mul_i32 s57, s52, 786432
s_lshl_b32 s58, s100, 6
s_add_u32 s57, s57, s58
buffer_load_dword v72, v10, s[24:27], s57 offen nt
s_add_u32 s57, s57, 6144
buffer_load_dword v73, v10, s[24:27], s57 offen nt
s_add_u32 s57, s57, 6144
buffer_load_dword v74, v10, s[24:27], s57 offen nt
s_add_u32 s57, s57, 6144
buffer_load_dword v75, v10, s[24:27], s57 offen nt
s_add_u32 s57, s57, 6144
buffer_load_dword v76, v10, s[24:27], s57 offen nt
s_add_u32 s57, s57, 6144
buffer_load_dword v77, v10, s[24:27], s57 offen nt
s_add_u32 s57, s57, 6144
buffer_load_dword v78, v10, s[24:27], s57 offen nt
s_add_u32 s57, s57, 6144
buffer_load_dword v79, v10, s[24:27], s57 offen nt
s_add_u32 s57, s57, 6144
buffer_load_dword v80, v10, s[24:27], s57 offen nt
s_add_u32 s57, s57, 6144
buffer_load_dword v81, v10, s[24:27], s57 offen nt
s_add_u32 s57, s57, 6144
buffer_load_dword v82, v10, s[24:27], s57 offen nt
s_add_u32 s57, s57, 6144
buffer_load_dword v83, v10, s[24:27], s57 offen nt
s_add_u32 s57, s57, 6144
buffer_load_dword v84, v10, s[24:27], s57 offen nt
s_add_u32 s57, s57, 6144
buffer_load_dword v85, v10, s[24:27], s57 offen nt
s_add_u32 s57, s57, 6144
buffer_load_dword v86, v10, s[24:27], s57 offen nt
s_add_u32 s57, s57, 6144
buffer_load_dword v87, v10, s[24:27], s57 offen nt
s_add_u32 s57, s57, 6144
buffer_load_dword v88, v10, s[24:27], s57 offen nt
s_add_u32 s57, s57, 6144
buffer_load_dword v89, v10, s[24:27], s57 offen nt
s_add_u32 s57, s57, 6144
buffer_load_dword v90, v10, s[24:27], s57 offen nt
s_add_u32 s57, s57, 6144
buffer_load_dword v91, v10, s[24:27], s57 offen nt
s_add_u32 s57, s57, 6144
buffer_load_dword v92, v10, s[24:27], s57 offen nt
s_add_u32 s57, s57, 6144
buffer_load_dword v93, v10, s[24:27], s57 offen nt
s_add_u32 s57, s57, 6144
buffer_load_dword v94, v10, s[24:27], s57 offen nt
s_add_u32 s57, s57, 6144
buffer_load_dword v95, v10, s[24:27], s57 offen nt
s_add_u32 s57, s57, 6144
buffer_load_dword v96, v10, s[24:27], s57 offen nt
s_add_u32 s57, s57, 6144
buffer_load_dword v97, v10, s[24:27], s57 offen nt
s_add_u32 s57, s57, 6144
buffer_load_dword v98, v10, s[24:27], s57 offen nt
s_add_u32 s57, s57, 6144
buffer_load_dword v99, v10, s[24:27], s57 offen nt
s_add_u32 s57, s57, 6144
buffer_load_dword v100, v10, s[24:27], s57 offen nt
s_add_u32 s57, s57, 6144
buffer_load_dword v101, v10, s[24:27], s57 offen nt
s_add_u32 s57, s57, 6144
buffer_load_dword v102, v10, s[24:27], s57 offen nt
s_add_u32 s57, s57, 6144
buffer_load_dword v103, v10, s[24:27], s57 offen nt
s_waitcnt vmcnt(32)
v_lshlrev_b32 v24, 16, v16
v_and_b32 v25, s91, v16
v_lshlrev_b32 v26, 16, v17
v_and_b32 v27, s91, v17
v_lshlrev_b32 v28, 16, v18
v_and_b32 v29, s91, v18
v_lshlrev_b32 v30, 16, v19
v_and_b32 v31, s91, v19
v_mul_f32 v32, 0xbfb8aa3b, v24
v_mul_f32 v33, 0xbfb8aa3b, v25
v_mul_f32 v34, 0xbfb8aa3b, v26
v_mul_f32 v35, 0xbfb8aa3b, v27
v_mul_f32 v36, 0xbfb8aa3b, v28
v_mul_f32 v37, 0xbfb8aa3b, v29
v_mul_f32 v38, 0xbfb8aa3b, v30
v_mul_f32 v39, 0xbfb8aa3b, v31
v_exp_f32 v32, v32
v_exp_f32 v33, v33
v_exp_f32 v34, v34
v_exp_f32 v35, v35
v_exp_f32 v36, v36
v_exp_f32 v37, v37
v_exp_f32 v38, v38
v_exp_f32 v39, v39
s_nop 0
v_add_f32 v32, 1.0, v32
v_add_f32 v33, 1.0, v33
v_add_f32 v34, 1.0, v34
v_add_f32 v35, 1.0, v35
v_add_f32 v36, 1.0, v36
v_add_f32 v37, 1.0, v37
v_add_f32 v38, 1.0, v38
v_add_f32 v39, 1.0, v39
v_rcp_f32 v32, v32
v_rcp_f32 v33, v33
v_rcp_f32 v34, v34
v_rcp_f32 v35, v35
v_rcp_f32 v36, v36
v_rcp_f32 v37, v37
v_rcp_f32 v38, v38
v_rcp_f32 v39, v39
s_nop 0
v_mul_f32 v24, v24, v32
v_mul_f32 v25, v25, v33
v_mul_f32 v26, v26, v34
v_mul_f32 v27, v27, v35
v_mul_f32 v28, v28, v36
v_mul_f32 v29, v29, v37
v_mul_f32 v30, v30, v38
v_mul_f32 v31, v31, v39
v_cvt_pk_bf16_f32 v24, v24, v24
v_cvt_pk_bf16_f32 v25, v25, v25
v_cvt_pk_bf16_f32 v26, v26, v26
v_cvt_pk_bf16_f32 v27, v27, v27
v_cvt_pk_bf16_f32 v28, v28, v28
v_cvt_pk_bf16_f32 v29, v29, v29
v_cvt_pk_bf16_f32 v30, v30, v30
v_cvt_pk_bf16_f32 v31, v31, v31
s_nop 0
v_and_b32_dpp v32, v24, v4 quad_perm:[0,0,0,0] row_mask:0xf bank_mask:0xf
v_and_b32_dpp v33, v25, v4 quad_perm:[0,0,0,0] row_mask:0xf bank_mask:0xf
v_and_b32_dpp v34, v26, v4 quad_perm:[0,0,0,0] row_mask:0xf bank_mask:0xf
v_and_b32_dpp v35, v27, v4 quad_perm:[0,0,0,0] row_mask:0xf bank_mask:0xf
s_waitcnt vmcnt(28)
s_nop 0
v_mfma_f32_16x16x32_bf16 v[16:19], v[72:75], v[32:35], 0
v_and_b32_dpp v36, v28, v4 quad_perm:[0,0,0,0] row_mask:0xf bank_mask:0xf
v_and_b32_dpp v37, v29, v4 quad_perm:[0,0,0,0] row_mask:0xf bank_mask:0xf
v_and_b32_dpp v38, v30, v4 quad_perm:[0,0,0,0] row_mask:0xf bank_mask:0xf
v_and_b32_dpp v39, v31, v4 quad_perm:[0,0,0,0] row_mask:0xf bank_mask:0xf
s_waitcnt vmcnt(24)
s_nop 0
v_mfma_f32_16x16x32_bf16 v[16:19], v[76:79], v[36:39], v[16:19]
v_and_b32_dpp v32, v24, v4 quad_perm:[1,1,1,1] row_mask:0xf bank_mask:0xf
v_and_b32_dpp v33, v25, v4 quad_perm:[1,1,1,1] row_mask:0xf bank_mask:0xf
v_and_b32_dpp v34, v26, v4 quad_perm:[1,1,1,1] row_mask:0xf bank_mask:0xf
v_and_b32_dpp v35, v27, v4 quad_perm:[1,1,1,1] row_mask:0xf bank_mask:0xf
s_waitcnt vmcnt(20)
s_nop 0
v_mfma_f32_16x16x32_bf16 v[16:19], v[80:83], v[32:35], v[16:19]
v_and_b32_dpp v36, v28, v4 quad_perm:[1,1,1,1] row_mask:0xf bank_mask:0xf
v_and_b32_dpp v37, v29, v4 quad_perm:[1,1,1,1] row_mask:0xf bank_mask:0xf
v_and_b32_dpp v38, v30, v4 quad_perm:[1,1,1,1] row_mask:0xf bank_mask:0xf
v_and_b32_dpp v39, v31, v4 quad_perm:[1,1,1,1] row_mask:0xf bank_mask:0xf
s_waitcnt vmcnt(16)
s_nop 0
v_mfma_f32_16x16x32_bf16 v[16:19], v[84:87], v[36:39], v[16:19]
v_and_b32_dpp v32, v24, v4 quad_perm:[2,2,2,2] row_mask:0xf bank_mask:0xf
v_and_b32_dpp v33, v25, v4 quad_perm:[2,2,2,2] row_mask:0xf bank_mask:0xf
v_and_b32_dpp v34, v26, v4 quad_perm:[2,2,2,2] row_mask:0xf bank_mask:0xf
v_and_b32_dpp v35, v27, v4 quad_perm:[2,2,2,2] row_mask:0xf bank_mask:0xf
s_waitcnt vmcnt(12)
s_nop 0
v_mfma_f32_16x16x32_bf16 v[16:19], v[88:91], v[32:35], v[16:19]
v_and_b32_dpp v36, v28, v4 quad_perm:[2,2,2,2] row_mask:0xf bank_mask:0xf
v_and_b32_dpp v37, v29, v4 quad_perm:[2,2,2,2] row_mask:0xf bank_mask:0xf
v_and_b32_dpp v38, v30, v4 quad_perm:[2,2,2,2] row_mask:0xf bank_mask:0xf
v_and_b32_dpp v39, v31, v4 quad_perm:[2,2,2,2] row_mask:0xf bank_mask:0xf
s_waitcnt vmcnt(8)
s_nop 0
v_mfma_f32_16x16x32_bf16 v[16:19], v[92:95], v[36:39], v[16:19]
v_and_b32_dpp v32, v24, v4 quad_perm:[3,3,3,3] row_mask:0xf bank_mask:0xf
v_and_b32_dpp v33, v25, v4 quad_perm:[3,3,3,3] row_mask:0xf bank_mask:0xf
v_and_b32_dpp v34, v26, v4 quad_perm:[3,3,3,3] row_mask:0xf bank_mask:0xf
v_and_b32_dpp v35, v27, v4 quad_perm:[3,3,3,3] row_mask:0xf bank_mask:0xf
s_waitcnt vmcnt(4)
s_nop 0
v_mfma_f32_16x16x32_bf16 v[16:19], v[96:99], v[32:35], v[16:19]
v_and_b32_dpp v36, v28, v4 quad_perm:[3,3,3,3] row_mask:0xf bank_mask:0xf
v_and_b32_dpp v37, v29, v4 quad_perm:[3,3,3,3] row_mask:0xf bank_mask:0xf
v_and_b32_dpp v38, v30, v4 quad_perm:[3,3,3,3] row_mask:0xf bank_mask:0xf
v_and_b32_dpp v39, v31, v4 quad_perm:[3,3,3,3] row_mask:0xf bank_mask:0xf
s_waitcnt vmcnt(0)
s_nop 0
v_mfma_f32_16x16x32_bf16 v[16:19], v[100:103], v[36:39], v[16:19]
s_nop 7
s_lshl_b32 s57, s52, 10
v_add_u32 v10, s57, v15
ds_write_b128 v10, v[16:19] offset:0
s_waitcnt lgkmcnt(0)
v_mov_b32 v10, 41344
v_mov_b32 v11, 1
s_mov_b64 exec, 1
ds_add_u32 v10, v11
s_mov_b64 exec, -1
v_mov_b32 v10, 41344
s_mov_b32 s55, 0
L_lw_17:
ds_read_b32 v11, v10
s_waitcnt lgkmcnt(0)
v_readfirstlane_b32 s57, v11
s_add_u32 s55, s55, 1
s_cmp_ge_u32 s57, 4
s_cbranch_scc1 L_lwd_18
s_cmp_lt_u32 s55, 400000
s_cbranch_scc1 L_lw_17
L_lwd_18:
s_lshl_b32 s57, s52, 2
v_add_u32 v10, s57, v15
ds_read_b32 v24, v10 offset:0
ds_read_b32 v25, v10 offset:1024
ds_read_b32 v26, v10 offset:2048
ds_read_b32 v27, v10 offset:3072
s_waitcnt lgkmcnt(0)
v_add_f32 v24, v24, v25
v_add_f32 v26, v26, v27
v_add_f32 v24, v24, v26
v_cvt_pk_bf16_f32 v24, v24, v24
v_lshl_or_b32 v24, v24, 16, v1
v_mul_u32_u24 v10, 12288, v6
v_lshl_add_u32 v10, v5, 5, v10
v_and_b32 v11, 1, v0
v_lshl_add_u32 v10, v11, 2, v10
s_lshl_b32 s57, s100, 7
s_lshl_b32 s58, s52, 3
s_add_u32 s57, s57, s58
s_add_u32 s57, s57, 4096
s_mov_b32 exec_lo, 0x33333333
s_mov_b32 exec_hi, 0x33333333
buffer_store_dword v24, v10, s[12:15], s57 offen sc1
s_mov_b64 exec, -1
L_s_prep_done:
v_lshlrev_b32 v12, 17, v6
v_lshl_add_u32 v12, v7, 11, v12
v_lshl_add_u32 v12, v5, 4, v12
s_lshr_b32 s57, s95, 5
s_lshl_b32 s54, s57, 14
s_and_b32 s57, s52, 1
s_lshl_b32 s57, s57, 10
s_add_u32 s54, s54, s57
s_bfe_u32 s57, s95, 0x10002
s_lshl_b32 s57, s57, 1
s_lshr_b32 s58, s52, 1
s_add_u32 s57, s57, s58
s_lshl_b32 s57, s57, 8
s_add_u32 s54, s54, s57
s_bfe_u32 s57, s95, 0x20003
s_lshl_b32 s58, s57, 6
s_add_u32 s54, s54, s58
s_add_u32 s54, s54, 1048576
s_add_u32 s97, s54, 8192
v_lshlrev_b32 v13, 12, v6
v_lshl_add_u32 v13, v7, 4, v13
s_lshr_b32 s98, s95, 3
s_lshl_b32 s98, s98, 7
s_add_u32 s98, s98, 1572864
v_mov_b32 v10, 41356
s_mov_b32 s55, 0
L_lw_19:
ds_read_b32 v11, v10
s_waitcnt lgkmcnt(0)
v_readfirstlane_b32 s57, v11
s_add_u32 s55, s55, 1
s_cmp_ge_u32 s57, 8
s_cbranch_scc1 L_lwd_20
s_sleep 1
s_cmp_lt_u32 s55, 400000
s_cbranch_scc1 L_lw_19
L_lwd_20:
s_cmp_lt_u32 s2, 128
s_cbranch_scc1 L_s_t2w_done
s_cmp_ge_u32 s2, 184
s_cbranch_scc1 L_s_t2w_done
v_mov_b32 v10, 41364
s_mov_b32 s55, 0
L_lw_21:
ds_read_b32 v11, v10
s_waitcnt lgkmcnt(0)
v_readfirstlane_b32 s57, v11
s_add_u32 s55, s55, 1
s_cmp_ge_u32 s57, 2
s_cbranch_scc1 L_lwd_22
s_cmp_lt_u32 s55, 400000
s_cbranch_scc1 L_lw_21
L_lwd_22:
s_sub_u32 s57, s2, 128
s_and_b32 s100, s57, 7
s_mul_i32 s100, s100, 7
s_lshr_b32 s57, s57, 3
s_add_u32 s100, s100, s57
v_mul_u32_u24 v10, 114688, v5
v_and_b32 v11, 15, v0
v_lshl_add_u32 v10, v11, 2, v10
s_mul_i32 s57, s52, 458752
s_lshl_b32 s58, s100, 6
s_add_u32 s57, s57, s58
buffer_load_dword v72, v10, s[28:31], s57 offen nt
buffer_load_dword v104, v10, s[32:35], s57 offen nt
s_add_u32 s57, s57, 3584
buffer_load_dword v73, v10, s[28:31], s57 offen nt
buffer_load_dword v105, v10, s[32:35], s57 offen nt
s_add_u32 s57, s57, 3584
buffer_load_dword v74, v10, s[28:31], s57 offen nt
buffer_load_dword v106, v10, s[32:35], s57 offen nt
s_add_u32 s57, s57, 3584
buffer_load_dword v75, v10, s[28:31], s57 offen nt
buffer_load_dword v107, v10, s[32:35], s57 offen nt
s_add_u32 s57, s57, 3584
buffer_load_dword v76, v10, s[28:31], s57 offen nt
buffer_load_dword v108, v10, s[32:35], s57 offen nt
s_add_u32 s57, s57, 3584
buffer_load_dword v77, v10, s[28:31], s57 offen nt
buffer_load_dword v109, v10, s[32:35], s57 offen nt
s_add_u32 s57, s57, 3584
buffer_load_dword v78, v10, s[28:31], s57 offen nt
buffer_load_dword v110, v10, s[32:35], s57 offen nt
s_add_u32 s57, s57, 3584
buffer_load_dword v79, v10, s[28:31], s57 offen nt
buffer_load_dword v111, v10, s[32:35], s57 offen nt
s_add_u32 s57, s57, 3584
buffer_load_dword v80, v10, s[28:31], s57 offen nt
buffer_load_dword v112, v10, s[32:35], s57 offen nt
s_add_u32 s57, s57, 3584
buffer_load_dword v81, v10, s[28:31], s57 offen nt
buffer_load_dword v113, v10, s[32:35], s57 offen nt
s_add_u32 s57, s57, 3584
buffer_load_dword v82, v10, s[28:31], s57 offen nt
buffer_load_dword v114, v10, s[32:35], s57 offen nt
s_add_u32 s57, s57, 3584
buffer_load_dword v83, v10, s[28:31], s57 offen nt
buffer_load_dword v115, v10, s[32:35], s57 offen nt
s_add_u32 s57, s57, 3584
buffer_load_dword v84, v10, s[28:31], s57 offen nt
buffer_load_dword v116, v10, s[32:35], s57 offen nt
s_add_u32 s57, s57, 3584
buffer_load_dword v85, v10, s[28:31], s57 offen nt
buffer_load_dword v117, v10, s[32:35], s57 offen nt
s_add_u32 s57, s57, 3584
buffer_load_dword v86, v10, s[28:31], s57 offen nt
buffer_load_dword v118, v10, s[32:35], s57 offen nt
s_add_u32 s57, s57, 3584
buffer_load_dword v87, v10, s[28:31], s57 offen nt
buffer_load_dword v119, v10, s[32:35], s57 offen nt
s_add_u32 s57, s57, 3584
buffer_load_dword v88, v10, s[28:31], s57 offen nt
buffer_load_dword v120, v10, s[32:35], s57 offen nt
s_add_u32 s57, s57, 3584
buffer_load_dword v89, v10, s[28:31], s57 offen nt
buffer_load_dword v121, v10, s[32:35], s57 offen nt
s_add_u32 s57, s57, 3584
buffer_load_dword v90, v10, s[28:31], s57 offen nt
buffer_load_dword v122, v10, s[32:35], s57 offen nt
s_add_u32 s57, s57, 3584
buffer_load_dword v91, v10, s[28:31], s57 offen nt
buffer_load_dword v123, v10, s[32:35], s57 offen nt
s_add_u32 s57, s57, 3584
buffer_load_dword v92, v10, s[28:31], s57 offen nt
buffer_load_dword v124, v10, s[32:35], s57 offen nt
s_add_u32 s57, s57, 3584
buffer_load_dword v93, v10, s[28:31], s57 offen nt
buffer_load_dword v125, v10, s[32:35], s57 offen nt
s_add_u32 s57, s57, 3584
buffer_load_dword v94, v10, s[28:31], s57 offen nt
buffer_load_dword v126, v10, s[32:35], s57 offen nt
s_add_u32 s57, s57, 3584
buffer_load_dword v95, v10, s[28:31], s57 offen nt
buffer_load_dword v127, v10, s[32:35], s57 offen nt
s_add_u32 s57, s57, 3584
buffer_load_dword v96, v10, s[28:31], s57 offen nt
buffer_load_dword v128, v10, s[32:35], s57 offen nt
s_add_u32 s57, s57, 3584
buffer_load_dword v97, v10, s[28:31], s57 offen nt
buffer_load_dword v129, v10, s[32:35], s57 offen nt
s_add_u32 s57, s57, 3584
buffer_load_dword v98, v10, s[28:31], s57 offen nt
buffer_load_dword v130, v10, s[32:35], s57 offen nt
s_add_u32 s57, s57, 3584
buffer_load_dword v99, v10, s[28:31], s57 offen nt
buffer_load_dword v131, v10, s[32:35], s57 offen nt
s_add_u32 s57, s57, 3584
buffer_load_dword v100, v10, s[28:31], s57 offen nt
buffer_load_dword v132, v10, s[32:35], s57 offen nt
s_add_u32 s57, s57, 3584
buffer_load_dword v101, v10, s[28:31], s57 offen nt
buffer_load_dword v133, v10, s[32:35], s57 offen nt
s_add_u32 s57, s57, 3584
buffer_load_dword v102, v10, s[28:31], s57 offen nt
buffer_load_dword v134, v10, s[32:35], s57 offen nt
s_add_u32 s57, s57, 3584
buffer_load_dword v103, v10, s[28:31], s57 offen nt
buffer_load_dword v135, v10, s[32:35], s57 offen nt
L_s_t2w_done:
s_mov_b32 s55, 0
s_mov_b32 s99, 0xffff
s_mov_b32 s101, 0xffff
L_pg_23:
s_mul_i32 s57, s101, 0x10001
s_mov_b32 exec_lo, s57
s_mov_b32 exec_hi, s57
s_cbranch_execz L_pgs_25
buffer_load_dwordx4 v[16:19], v12, s[12:15], s54 offen sc1
buffer_load_dwordx4 v[20:23], v12, s[12:15], s97 offen sc1
L_pgs_25:
s_mul_i32 s57, s99, 0x10001
s_mov_b32 exec_lo, s57
s_mov_b32 exec_hi, s57
buffer_load_dwordx4 v[24:27], v13, s[12:15], s98 offen sc1
buffer_load_dwordx4 v[28:31], v13, s[12:15], s98 offen offset:64 sc1
s_waitcnt vmcnt(0)
v_bitop3_b32 v10, v24, v25, v26 bitop3:0x80
v_or3_b32 v11, v24, v25, v26
v_bitop3_b32 v10, v10, v27, v28 bitop3:0x80
v_or3_b32 v11, v11, v27, v28
v_bitop3_b32 v10, v10, v29, v30 bitop3:0x80
v_or3_b32 v11, v11, v29, v30
v_bitop3_b32 v10, v10, v31, v31 bitop3:0x80
v_or3_b32 v11, v11, v31, v31
v_bitop3_b32 v10, v10, v11, v1 bitop3:0x7e
v_bitop3_b32 v8, v16, v17, v18 bitop3:0x80
v_or3_b32 v9, v16, v17, v18
v_bitop3_b32 v8, v8, v19, v20 bitop3:0x80
v_or3_b32 v9, v9, v19, v20
v_bitop3_b32 v8, v8, v21, v22 bitop3:0x80
v_or3_b32 v9, v9, v21, v22
v_bitop3_b32 v8, v8, v23, v23 bitop3:0x80
v_or3_b32 v9, v9, v23, v23
v_bitop3_b32 v8, v8, v9, v1 bitop3:0x7e
v_lshlrev_b32 v10, 16, v10
v_lshlrev_b32 v8, 28, v8
v_cmp_ne_u32 vcc, 0, v10
s_or_b32 s96, vcc_lo, vcc_hi
s_lshr_b32 s57, s96, 16
s_or_b32 s96, s96, s57
s_and_b32 s96, s96, 0xffff
v_cmp_ne_u32 vcc, 0, v8
s_or_b32 s99, vcc_lo, vcc_hi
s_lshr_b32 s57, s99, 16
s_or_b32 s99, s99, s57
s_and_b32 s99, s99, 0xffff
s_or_b32 s99, s99, s96
s_cmp_eq_u32 s99, 0
s_cbranch_scc1 L_pgd_24
s_andn2_b32 s101, s99, s96
s_bcnt1_i32_b32 s57, s99
s_cmp_le_u32 s57, 4
s_cselect_b32 s101, s99, s101
s_add_u32 s55, s55, 1
s_cmp_lt_u32 s55, 4000
s_cbranch_scc1 L_pg_23
L_pgd_24:
s_mov_b64 exec, -1
v_and_b32 v24, s91, v24
v_and_b32 v28, s91, v28
v_lshrrev_b32 v26, 16, v26
v_lshrrev_b32 v30, 16, v30
v_and_or_b32 v25, v25, s91, v26
v_and_or_b32 v29, v29, s91, v30
v_max_f32 v10, v24, v28
s_nop 1
v_max_f32_dpp v10, v10, v10 quad_perm:[1,0,3,2] row_mask:0xf bank_mask:0xf
s_nop 1
v_max_f32_dpp v10, v10, v10 quad_perm:[2,3,0,1] row_mask:0xf bank_mask:0xf
v_sub_f32 v24, v24, v10
v_sub_f32 v28, v28, v10
v_mul_f32 v24, 0x3fb8aa3b, v24
v_mul_f32 v28, 0x3fb8aa3b, v28
v_exp_f32 v24, v24
v_exp_f32 v28, v28
s_nop 0
v_mul_f32 v25, v24, v25
v_fmac_f32 v25, v28, v29
v_mul_f32 v16, v24, v16
v_mul_f32 v17, v24, v17
v_mul_f32 v18, v24, v18
v_mul_f32 v19, v24, v19
v_fmac_f32 v16, v28, v20
v_fmac_f32 v17, v28, v21
v_fmac_f32 v18, v28, v22
v_fmac_f32 v19, v28, v23
s_nop 1
v_add_f32_dpp v25, v25, v25 quad_perm:[1,0,3,2] row_mask:0xf bank_mask:0xf
v_add_f32_dpp v16, v16, v16 quad_perm:[1,0,3,2] row_mask:0xf bank_mask:0xf
v_add_f32_dpp v17, v17, v17 quad_perm:[1,0,3,2] row_mask:0xf bank_mask:0xf
v_add_f32_dpp v18, v18, v18 quad_perm:[1,0,3,2] row_mask:0xf bank_mask:0xf
v_add_f32_dpp v19, v19, v19 quad_perm:[1,0,3,2] row_mask:0xf bank_mask:0xf
v_add_f32_dpp v25, v25, v25 quad_perm:[2,3,0,1] row_mask:0xf bank_mask:0xf
v_add_f32_dpp v16, v16, v16 quad_perm:[2,3,0,1] row_mask:0xf bank_mask:0xf
v_add_f32_dpp v17, v17, v17 quad_perm:[2,3,0,1] row_mask:0xf bank_mask:0xf
v_add_f32_dpp v18, v18, v18 quad_perm:[2,3,0,1] row_mask:0xf bank_mask:0xf
v_add_f32_dpp v19, v19, v19 quad_perm:[2,3,0,1] row_mask:0xf bank_mask:0xf
v_rcp_f32 v25, v25
s_nop 0
v_mul_f32 v16, v16, v25
v_mul_f32 v17, v17, v25
v_mul_f32 v18, v18, v25
v_mul_f32 v19, v19, v25
v_cvt_pk_bf16_f32 v16, v16, v16
v_cvt_pk_bf16_f32 v17, v17, v17
v_cvt_pk_bf16_f32 v18, v18, v18
v_cvt_pk_bf16_f32 v19, v19, v19
v_and_b32 v160, v16, v2
v_and_b32 v161, v16, v3
v_and_b32 v162, v17, v2
v_and_b32 v163, v17, v3
v_and_b32 v164, v18, v2
v_and_b32 v165, v18, v3
v_and_b32 v166, v19, v2
v_and_b32 v167, v19, v3
s_nop 1
v_mfma_f32_16x16x16_bf16 v[20:23], v[56:57], v[160:161], 0
v_mfma_f32_16x16x16_bf16 v[24:27], v[58:59], v[160:161], 0
v_mfma_f32_16x16x16_bf16 v[20:23], v[60:61], v[162:163], v[20:23]
v_mfma_f32_16x16x16_bf16 v[24:27], v[62:63], v[162:163], v[24:27]
v_mfma_f32_16x16x16_bf16 v[20:23], v[64:65], v[164:165], v[20:23]
v_mfma_f32_16x16x16_bf16 v[24:27], v[66:67], v[164:165], v[24:27]
v_mfma_f32_16x16x16_bf16 v[20:23], v[68:69], v[166:167], v[20:23]
v_mfma_f32_16x16x16_bf16 v[24:27], v[70:71], v[166:167], v[24:27]
s_nop 7
s_lshl_b32 s57, s52, 11
v_add_u32 v10, s57, v15
ds_write_b128 v10, v[20:23] offset:4096
ds_write_b128 v10, v[24:27] offset:5120
s_waitcnt lgkmcnt(0)
s_barrier
s_cmp_ge_u32 s52, 2
s_cbranch_scc1 L_crs_27
s_and_b32 s57, s52, 1
s_lshl_b32 s57, s57, 10
v_add_u32 v10, s57, v15
ds_read_b128 v[56:59], v10 offset:4096
ds_read_b128 v[60:63], v10 offset:6144
ds_read_b128 v[64:67], v10 offset:8192
ds_read_b128 v[68:71], v10 offset:10240
s_lshl_b32 s57, s95, 11
s_add_u32 s57, s57, 2097152
s_waitcnt lgkmcnt(0)
v_add_f32 v56, v56, v60
v_add_f32 v64, v64, v68
v_add_f32 v57, v57, v61
v_add_f32 v65, v65, v69
v_add_f32 v58, v58, v62
v_add_f32 v66, v66, v70
v_add_f32 v59, v59, v63
v_add_f32 v67, v67, v71
v_add_f32 v56, v56, v64
v_add_f32 v57, v57, v65
v_add_f32 v58, v58, v66
v_add_f32 v59, v59, v67
v_and_or_b32 v56, v56, -16, s94
v_and_or_b32 v57, v57, -16, s94
v_and_or_b32 v58, v58, -16, s94
v_and_or_b32 v59, v59, -16, s94
buffer_store_dwordx4 v[56:59], v10, s[12:15], s57 offen sc1
L_crs_27:
s_cmp_lt_u32 s2, 128
s_cbranch_scc1 L_s_r
s_cmp_ge_u32 s2, 184
s_cbranch_scc1 L_end
v_lshl_add_u32 v10, v5, 13, v14
s_lshl_b32 s57, s100, 15
s_lshl_b32 s58, s52, 8
s_add_u32 s57, s57, s58
buffer_load_dwordx4 v[136:139], v10, s[36:39], s57 offen nt
s_add_u32 s57, s57, 1024
buffer_load_dwordx4 v[140:143], v10, s[36:39], s57 offen nt
s_add_u32 s57, s57, 1024
buffer_load_dwordx4 v[144:147], v10, s[36:39], s57 offen nt
s_add_u32 s57, s57, 1024
buffer_load_dwordx4 v[148:151], v10, s[36:39], s57 offen nt
s_add_u32 s57, s57, 1024
buffer_load_dwordx4 v[152:155], v10, s[36:39], s57 offen nt
s_add_u32 s57, s57, 1024
buffer_load_dwordx4 v[156:159], v10, s[36:39], s57 offen nt
s_add_u32 s57, s57, 1024
buffer_load_dwordx4 v[160:163], v10, s[36:39], s57 offen nt
s_add_u32 s57, s57, 1024
buffer_load_dwordx4 v[164:167], v10, s[36:39], s57 offen nt
v_mul_u32_u24 v12, 12288, v6
v_lshl_add_u32 v12, v5, 7, v12
v_lshl_add_u32 v12, v7, 5, v12
s_lshl_b32 s54, s52, 9
s_add_u32 s54, s54, 10240
s_mov_b32 s55, 0
L_poll_28:
buffer_load_dwordx4 v[16:19], v12, s[12:15], s54 offen sc1
buffer_load_dwordx4 v[20:23], v12, s[12:15], s54 offen offset:16 sc1
buffer_load_dwordx4 v[24:27], v12, s[12:15], s54 offen offset:2048 sc1
buffer_load_dwordx4 v[28:31], v12, s[12:15], s54 offen offset:2064 sc1
s_waitcnt vmcnt(0)
v_bitop3_b32 v8, v16, v17, v18 bitop3:0x80
v_or3_b32 v9, v16, v17, v18
v_bitop3_b32 v8, v8, v19, v20 bitop3:0x80
v_or3_b32 v9, v9, v19, v20
v_bitop3_b32 v8, v8, v21, v22 bitop3:0x80
v_or3_b32 v9, v9, v21, v22
v_bitop3_b32 v8, v8, v23, v24 bitop3:0x80
v_or3_b32 v9, v9, v23, v24
v_bitop3_b32 v8, v8, v25, v26 bitop3:0x80
v_or3_b32 v9, v9, v25, v26
v_bitop3_b32 v8, v8, v27, v28 bitop3:0x80
v_or3_b32 v9, v9, v27, v28
v_bitop3_b32 v8, v8, v29, v30 bitop3:0x80
v_or3_b32 v9, v9, v29, v30
v_bitop3_b32 v8, v8, v31, v31 bitop3:0x80
v_or3_b32 v9, v9, v31, v31
v_xor_b32 v8, v8, v1
v_xor_b32 v9, v9, v1
v_or_b32 v8, v8, v9
v_and_b32 v8, 0xffff, v8
v_cmp_ne_u32 vcc, 0, v8
s_add_u32 s55, s55, 1
s_cmp_lt_u32 s55, 4000
s_cbranch_scc0 L_pd_29
s_cbranch_vccnz L_poll_28
L_pd_29:
v_and_b32 v40, s91, v16
v_and_b32 v24, s91, v24
v_and_b32 v41, s91, v17
v_and_b32 v25, s91, v25
v_and_b32 v42, s91, v18
v_and_b32 v26, s91, v26
v_and_b32 v43, s91, v19
v_and_b32 v27, s91, v27
v_and_b32 v44, s91, v20
v_and_b32 v28, s91, v28
v_and_b32 v45, s91, v21
v_and_b32 v29, s91, v29
v_and_b32 v46, s91, v22
v_and_b32 v30, s91, v30
v_and_b32 v47, s91, v23
v_and_b32 v31, s91, v31
v_add_f32 v48, 1.0, v24
v_add_f32 v49, 1.0, v25
v_add_f32 v50, 1.0, v26
v_add_f32 v51, 1.0, v27
v_add_f32 v52, 1.0, v28
v_add_f32 v53, 1.0, v29
v_add_f32 v54, 1.0, v30
v_add_f32 v55, 1.0, v31
v_cvt_pk_bf16_f32 v10, v48, v49
v_lshlrev_b32 v48, 16, v10
v_and_b32 v49, s91, v10
v_cvt_pk_bf16_f32 v11, v50, v51
v_lshlrev_b32 v50, 16, v11
v_and_b32 v51, s91, v11
v_cvt_pk_bf16_f32 v10, v52, v53
v_lshlrev_b32 v52, 16, v10
v_and_b32 v53, s91, v10
v_cvt_pk_bf16_f32 v11, v54, v55
v_lshlrev_b32 v54, 16, v11
v_and_b32 v55, s91, v11
v_lshlrev_b32 v64, 9, v6
v_lshl_add_u32 v64, v5, 7, v64
v_lshl_add_u32 v65, v7, 5, v64
v_and_b32 v11, 1, v0
v_lshl_add_u32 v64, v11, 4, v64
s_lshl_b32 s57, s52, 2
v_add_u32 v64, s57, v64
v_cvt_pk_bf16_f32 v16, v48, v48
v_cvt_pk_bf16_f32 v17, v49, v49
v_cvt_pk_bf16_f32 v18, v50, v50
v_cvt_pk_bf16_f32 v19, v51, v51
v_cvt_pk_bf16_f32 v20, v52, v52
v_cvt_pk_bf16_f32 v21, v53, v53
v_cvt_pk_bf16_f32 v22, v54, v54
v_cvt_pk_bf16_f32 v23, v55, v55
v_cvt_pk_bf16_f32 v32, v40, v40
v_cvt_pk_bf16_f32 v33, v41, v41
v_cvt_pk_bf16_f32 v34, v42, v42
v_cvt_pk_bf16_f32 v35, v43, v43
v_cvt_pk_bf16_f32 v36, v44, v44
v_cvt_pk_bf16_f32 v37, v45, v45
v_cvt_pk_bf16_f32 v38, v46, v46
v_cvt_pk_bf16_f32 v39, v47, v47
s_waitcnt vmcnt(0)
v_and_b32_dpp v56, v16, v4 quad_perm:[0,0,0,0] row_mask:0xf bank_mask:0xf
v_and_b32_dpp v57, v17, v4 quad_perm:[0,0,0,0] row_mask:0xf bank_mask:0xf
v_and_b32_dpp v58, v18, v4 quad_perm:[0,0,0,0] row_mask:0xf bank_mask:0xf
v_and_b32_dpp v59, v19, v4 quad_perm:[0,0,0,0] row_mask:0xf bank_mask:0xf
s_nop 1
v_mfma_f32_16x16x32_bf16 v[24:27], v[72:75], v[56:59], 0
v_mfma_f32_16x16x32_bf16 v[28:31], v[104:107], v[56:59], 0
v_and_b32_dpp v60, v20, v4 quad_perm:[0,0,0,0] row_mask:0xf bank_mask:0xf
v_and_b32_dpp v61, v21, v4 quad_perm:[0,0,0,0] row_mask:0xf bank_mask:0xf
v_and_b32_dpp v62, v22, v4 quad_perm:[0,0,0,0] row_mask:0xf bank_mask:0xf
v_and_b32_dpp v63, v23, v4 quad_perm:[0,0,0,0] row_mask:0xf bank_mask:0xf
s_nop 1
v_mfma_f32_16x16x32_bf16 v[24:27], v[76:79], v[60:63], v[24:27]
v_mfma_f32_16x16x32_bf16 v[28:31], v[108:111], v[60:63], v[28:31]
v_and_b32_dpp v56, v16, v4 quad_perm:[1,1,1,1] row_mask:0xf bank_mask:0xf
v_and_b32_dpp v57, v17, v4 quad_perm:[1,1,1,1] row_mask:0xf bank_mask:0xf
v_and_b32_dpp v58, v18, v4 quad_perm:[1,1,1,1] row_mask:0xf bank_mask:0xf
v_and_b32_dpp v59, v19, v4 quad_perm:[1,1,1,1] row_mask:0xf bank_mask:0xf
s_nop 1
v_mfma_f32_16x16x32_bf16 v[24:27], v[80:83], v[56:59], v[24:27]
v_mfma_f32_16x16x32_bf16 v[28:31], v[112:115], v[56:59], v[28:31]
v_and_b32_dpp v60, v20, v4 quad_perm:[1,1,1,1] row_mask:0xf bank_mask:0xf
v_and_b32_dpp v61, v21, v4 quad_perm:[1,1,1,1] row_mask:0xf bank_mask:0xf
v_and_b32_dpp v62, v22, v4 quad_perm:[1,1,1,1] row_mask:0xf bank_mask:0xf
v_and_b32_dpp v63, v23, v4 quad_perm:[1,1,1,1] row_mask:0xf bank_mask:0xf
s_nop 1
v_mfma_f32_16x16x32_bf16 v[24:27], v[84:87], v[60:63], v[24:27]
v_mfma_f32_16x16x32_bf16 v[28:31], v[116:119], v[60:63], v[28:31]
v_and_b32_dpp v56, v16, v4 quad_perm:[2,2,2,2] row_mask:0xf bank_mask:0xf
v_and_b32_dpp v57, v17, v4 quad_perm:[2,2,2,2] row_mask:0xf bank_mask:0xf
v_and_b32_dpp v58, v18, v4 quad_perm:[2,2,2,2] row_mask:0xf bank_mask:0xf
v_and_b32_dpp v59, v19, v4 quad_perm:[2,2,2,2] row_mask:0xf bank_mask:0xf
s_nop 1
v_mfma_f32_16x16x32_bf16 v[24:27], v[88:91], v[56:59], v[24:27]
v_mfma_f32_16x16x32_bf16 v[28:31], v[120:123], v[56:59], v[28:31]
v_and_b32_dpp v60, v20, v4 quad_perm:[2,2,2,2] row_mask:0xf bank_mask:0xf
v_and_b32_dpp v61, v21, v4 quad_perm:[2,2,2,2] row_mask:0xf bank_mask:0xf
v_and_b32_dpp v62, v22, v4 quad_perm:[2,2,2,2] row_mask:0xf bank_mask:0xf
v_and_b32_dpp v63, v23, v4 quad_perm:[2,2,2,2] row_mask:0xf bank_mask:0xf
s_nop 1
v_mfma_f32_16x16x32_bf16 v[24:27], v[92:95], v[60:63], v[24:27]
v_mfma_f32_16x16x32_bf16 v[28:31], v[124:127], v[60:63], v[28:31]
v_and_b32_dpp v56, v16, v4 quad_perm:[3,3,3,3] row_mask:0xf bank_mask:0xf
v_and_b32_dpp v57, v17, v4 quad_perm:[3,3,3,3] row_mask:0xf bank_mask:0xf
v_and_b32_dpp v58, v18, v4 quad_perm:[3,3,3,3] row_mask:0xf bank_mask:0xf
v_and_b32_dpp v59, v19, v4 quad_perm:[3,3,3,3] row_mask:0xf bank_mask:0xf
s_nop 1
v_mfma_f32_16x16x32_bf16 v[24:27], v[96:99], v[56:59], v[24:27]
v_mfma_f32_16x16x32_bf16 v[28:31], v[128:131], v[56:59], v[28:31]
v_and_b32_dpp v60, v20, v4 quad_perm:[3,3,3,3] row_mask:0xf bank_mask:0xf
v_and_b32_dpp v61, v21, v4 quad_perm:[3,3,3,3] row_mask:0xf bank_mask:0xf
v_and_b32_dpp v62, v22, v4 quad_perm:[3,3,3,3] row_mask:0xf bank_mask:0xf
v_and_b32_dpp v63, v23, v4 quad_perm:[3,3,3,3] row_mask:0xf bank_mask:0xf
s_nop 1
v_mfma_f32_16x16x32_bf16 v[24:27], v[100:103], v[60:63], v[24:27]
v_mfma_f32_16x16x32_bf16 v[28:31], v[132:135], v[60:63], v[28:31]
s_nop 7
s_nop 5
s_mov_b32 exec_lo, 0x33333333
s_mov_b32 exec_hi, 0x33333333
ds_write_b32 v64, v24 offset:24576
ds_write_b32 v64, v28 offset:26624
ds_write_b32 v64, v25 offset:24608
ds_write_b32 v64, v29 offset:26656
ds_write_b32 v64, v26 offset:24640
ds_write_b32 v64, v30 offset:26688
ds_write_b32 v64, v27 offset:24672
ds_write_b32 v64, v31 offset:26720
s_mov_b64 exec, -1
v_and_b32_dpp v56, v32, v4 quad_perm:[0,0,0,0] row_mask:0xf bank_mask:0xf
v_and_b32_dpp v57, v33, v4 quad_perm:[0,0,0,0] row_mask:0xf bank_mask:0xf
v_and_b32_dpp v58, v34, v4 quad_perm:[0,0,0,0] row_mask:0xf bank_mask:0xf
v_and_b32_dpp v59, v35, v4 quad_perm:[0,0,0,0] row_mask:0xf bank_mask:0xf
s_nop 1
v_mfma_f32_16x16x32_bf16 v[16:19], v[72:75], v[56:59], 0
v_mfma_f32_16x16x32_bf16 v[20:23], v[104:107], v[56:59], 0
v_and_b32_dpp v60, v36, v4 quad_perm:[0,0,0,0] row_mask:0xf bank_mask:0xf
v_and_b32_dpp v61, v37, v4 quad_perm:[0,0,0,0] row_mask:0xf bank_mask:0xf
v_and_b32_dpp v62, v38, v4 quad_perm:[0,0,0,0] row_mask:0xf bank_mask:0xf
v_and_b32_dpp v63, v39, v4 quad_perm:[0,0,0,0] row_mask:0xf bank_mask:0xf
s_nop 1
v_mfma_f32_16x16x32_bf16 v[16:19], v[76:79], v[60:63], v[16:19]
v_mfma_f32_16x16x32_bf16 v[20:23], v[108:111], v[60:63], v[20:23]
v_and_b32_dpp v56, v32, v4 quad_perm:[1,1,1,1] row_mask:0xf bank_mask:0xf
v_and_b32_dpp v57, v33, v4 quad_perm:[1,1,1,1] row_mask:0xf bank_mask:0xf
v_and_b32_dpp v58, v34, v4 quad_perm:[1,1,1,1] row_mask:0xf bank_mask:0xf
v_and_b32_dpp v59, v35, v4 quad_perm:[1,1,1,1] row_mask:0xf bank_mask:0xf
s_nop 1
v_mfma_f32_16x16x32_bf16 v[16:19], v[80:83], v[56:59], v[16:19]
v_mfma_f32_16x16x32_bf16 v[20:23], v[112:115], v[56:59], v[20:23]
v_and_b32_dpp v60, v36, v4 quad_perm:[1,1,1,1] row_mask:0xf bank_mask:0xf
v_and_b32_dpp v61, v37, v4 quad_perm:[1,1,1,1] row_mask:0xf bank_mask:0xf
v_and_b32_dpp v62, v38, v4 quad_perm:[1,1,1,1] row_mask:0xf bank_mask:0xf
v_and_b32_dpp v63, v39, v4 quad_perm:[1,1,1,1] row_mask:0xf bank_mask:0xf
s_nop 1
v_mfma_f32_16x16x32_bf16 v[16:19], v[84:87], v[60:63], v[16:19]
v_mfma_f32_16x16x32_bf16 v[20:23], v[116:119], v[60:63], v[20:23]
v_and_b32_dpp v56, v32, v4 quad_perm:[2,2,2,2] row_mask:0xf bank_mask:0xf
v_and_b32_dpp v57, v33, v4 quad_perm:[2,2,2,2] row_mask:0xf bank_mask:0xf
v_and_b32_dpp v58, v34, v4 quad_perm:[2,2,2,2] row_mask:0xf bank_mask:0xf
v_and_b32_dpp v59, v35, v4 quad_perm:[2,2,2,2] row_mask:0xf bank_mask:0xf
s_nop 1
v_mfma_f32_16x16x32_bf16 v[16:19], v[88:91], v[56:59], v[16:19]
v_mfma_f32_16x16x32_bf16 v[20:23], v[120:123], v[56:59], v[20:23]
v_and_b32_dpp v60, v36, v4 quad_perm:[2,2,2,2] row_mask:0xf bank_mask:0xf
v_and_b32_dpp v61, v37, v4 quad_perm:[2,2,2,2] row_mask:0xf bank_mask:0xf
v_and_b32_dpp v62, v38, v4 quad_perm:[2,2,2,2] row_mask:0xf bank_mask:0xf
v_and_b32_dpp v63, v39, v4 quad_perm:[2,2,2,2] row_mask:0xf bank_mask:0xf
s_nop 1
v_mfma_f32_16x16x32_bf16 v[16:19], v[92:95], v[60:63], v[16:19]
v_mfma_f32_16x16x32_bf16 v[20:23], v[124:127], v[60:63], v[20:23]
v_and_b32_dpp v56, v32, v4 quad_perm:[3,3,3,3] row_mask:0xf bank_mask:0xf
v_and_b32_dpp v57, v33, v4 quad_perm:[3,3,3,3] row_mask:0xf bank_mask:0xf
v_and_b32_dpp v58, v34, v4 quad_perm:[3,3,3,3] row_mask:0xf bank_mask:0xf
v_and_b32_dpp v59, v35, v4 quad_perm:[3,3,3,3] row_mask:0xf bank_mask:0xf
s_nop 1
v_mfma_f32_16x16x32_bf16 v[16:19], v[96:99], v[56:59], v[16:19]
v_mfma_f32_16x16x32_bf16 v[20:23], v[128:131], v[56:59], v[20:23]
v_and_b32_dpp v60, v36, v4 quad_perm:[3,3,3,3] row_mask:0xf bank_mask:0xf
v_and_b32_dpp v61, v37, v4 quad_perm:[3,3,3,3] row_mask:0xf bank_mask:0xf
v_and_b32_dpp v62, v38, v4 quad_perm:[3,3,3,3] row_mask:0xf bank_mask:0xf
v_and_b32_dpp v63, v39, v4 quad_perm:[3,3,3,3] row_mask:0xf bank_mask:0xf
s_nop 1
v_mfma_f32_16x16x32_bf16 v[16:19], v[100:103], v[60:63], v[16:19]
v_mfma_f32_16x16x32_bf16 v[20:23], v[132:135], v[60:63], v[20:23]
s_nop 7
s_nop 5
s_mov_b32 exec_lo, 0x33333333
s_mov_b32 exec_hi, 0x33333333
ds_write_b32 v64, v16 offset:28672
ds_write_b32 v64, v20 offset:30720
ds_write_b32 v64, v17 offset:28704
ds_write_b32 v64, v21 offset:30752
ds_write_b32 v64, v18 offset:28736
ds_write_b32 v64, v22 offset:30784
ds_write_b32 v64, v19 offset:28768
ds_write_b32 v64, v23 offset:30816
s_mov_b64 exec, -1
s_waitcnt lgkmcnt(0)
s_barrier
ds_read_b128 v[16:19], v65 offset:24576
ds_read_b128 v[20:23], v65 offset:24592
ds_read_b128 v[24:27], v65 offset:26624
ds_read_b128 v[28:31], v65 offset:26640
s_waitcnt lgkmcnt(0)
v_add_f32 v16, v16, v17
v_add_f32 v18, v18, v19
v_add_f32 v20, v20, v21
v_add_f32 v22, v22, v23
v_add_f32 v24, v24, v25
v_add_f32 v26, v26, v27
v_add_f32 v28, v28, v29
v_add_f32 v30, v30, v31
v_add_f32 v16, v16, v18
v_add_f32 v20, v20, v22
v_add_f32 v24, v24, v26
v_add_f32 v28, v28, v30
v_mov_b32 v40, v16
v_mov_b32 v41, v20
v_mov_b32 v42, v24
v_mov_b32 v43, v28
ds_read_b128 v[16:19], v65 offset:28672
ds_read_b128 v[20:23], v65 offset:28688
ds_read_b128 v[24:27], v65 offset:30720
ds_read_b128 v[28:31], v65 offset:30736
s_waitcnt lgkmcnt(0)
v_add_f32 v16, v16, v17
v_add_f32 v18, v18, v19
v_add_f32 v20, v20, v21
v_add_f32 v22, v22, v23
v_add_f32 v24, v24, v25
v_add_f32 v26, v26, v27
v_add_f32 v28, v28, v29
v_add_f32 v30, v30, v31
v_add_f32 v16, v16, v18
v_add_f32 v20, v20, v22
v_add_f32 v24, v24, v26
v_add_f32 v28, v28, v30
v_mov_b32 v44, v16
v_mov_b32 v45, v20
v_mov_b32 v46, v24
v_mov_b32 v47, v28
v_lshlrev_b32 v12, 11, v6
v_lshl_add_u32 v12, v5, 7, v12
v_lshl_add_u32 v12, v7, 4, v12
s_lshl_b32 s54, s52, 9
s_add_u32 s54, s54, 2621440
v_lshlrev_b32 v13, 5, v6
s_lshl_b32 s57, s52, 3
v_add_u32 v11, s57, v13
s_mov_b32 s55, 0
L_p3_30:
buffer_load_dwordx4 v[16:19], v12, s[12:15], s54 offen sc1
buffer_load_dwordx4 v[20:23], v12, s[12:15], s54 offen offset:64 sc1
s_waitcnt vmcnt(0)
v_bitop3_b32 v8, v16, v17, v18 bitop3:0x80
v_or3_b32 v9, v16, v17, v18
v_bitop3_b32 v8, v8, v19, v20 bitop3:0x80
v_or3_b32 v9, v9, v19, v20
v_bitop3_b32 v8, v8, v21, v22 bitop3:0x80
v_or3_b32 v9, v9, v21, v22
v_bitop3_b32 v8, v8, v23, v23 bitop3:0x80
v_or3_b32 v9, v9, v23, v23
v_bitop3_b32 v8, v8, v9, v1 bitop3:0x7e
v_lshlrev_b32 v8, 16, v8
v_cmp_ne_u32 vcc, 0, v8
s_add_u32 s55, s55, 1
s_mov_b64 exec, vcc
s_cbranch_execz L_p3d_31
s_cmp_lt_u32 s55, 4000
s_cbranch_scc1 L_p3_30
L_p3d_31:
s_mov_b64 exec, -1
v_and_b32 v16, s91, v16
v_and_b32 v17, s91, v17
v_and_b32 v18, s91, v18
v_and_b32 v19, s91, v19
v_and_b32 v20, s91, v20
v_and_b32 v21, s91, v21
v_and_b32 v22, s91, v22
v_and_b32 v23, s91, v23
v_mul_f32 v32, v16, v48
v_mul_f32 v33, v17, v49
v_mul_f32 v34, v18, v50
v_mul_f32 v35, v19, v51
v_mul_f32 v36, v20, v52
v_mul_f32 v37, v21, v53
v_mul_f32 v38, v22, v54
v_mul_f32 v39, v23, v55
v_cvt_pk_bf16_f32 v32, v32, v32
v_cvt_pk_bf16_f32 v33, v33, v33
v_cvt_pk_bf16_f32 v34, v34, v34
v_cvt_pk_bf16_f32 v35, v35, v35
v_cvt_pk_bf16_f32 v36, v36, v36
v_cvt_pk_bf16_f32 v37, v37, v37
v_cvt_pk_bf16_f32 v38, v38, v38
v_cvt_pk_bf16_f32 v39, v39, v39
v_and_b32_dpp v56, v32, v4 quad_perm:[0,0,0,0] row_mask:0xf bank_mask:0xf
v_and_b32_dpp v57, v33, v4 quad_perm:[0,0,0,0] row_mask:0xf bank_mask:0xf
v_and_b32_dpp v58, v34, v4 quad_perm:[0,0,0,0] row_mask:0xf bank_mask:0xf
v_and_b32_dpp v59, v35, v4 quad_perm:[0,0,0,0] row_mask:0xf bank_mask:0xf
v_add_f32 v8, v16, v17
v_add_f32 v10, v18, v19
v_mfma_f32_16x16x32_bf16 v[24:27], v[72:75], v[56:59], 0
v_mfma_f32_16x16x32_bf16 v[28:31], v[104:107], v[56:59], 0
v_and_b32_dpp v60, v36, v4 quad_perm:[0,0,0,0] row_mask:0xf bank_mask:0xf
v_and_b32_dpp v61, v37, v4 quad_perm:[0,0,0,0] row_mask:0xf bank_mask:0xf
v_and_b32_dpp v62, v38, v4 quad_perm:[0,0,0,0] row_mask:0xf bank_mask:0xf
v_and_b32_dpp v63, v39, v4 quad_perm:[0,0,0,0] row_mask:0xf bank_mask:0xf
v_mul_f32 v9, v16, v16
v_mul_f32 v12, v17, v17
v_mfma_f32_16x16x32_bf16 v[24:27], v[76:79], v[60:63], v[24:27]
v_mfma_f32_16x16x32_bf16 v[28:31], v[108:111], v[60:63], v[28:31]
v_and_b32_dpp v56, v32, v4 quad_perm:[1,1,1,1] row_mask:0xf bank_mask:0xf
v_and_b32_dpp v57, v33, v4 quad_perm:[1,1,1,1] row_mask:0xf bank_mask:0xf
v_and_b32_dpp v58, v34, v4 quad_perm:[1,1,1,1] row_mask:0xf bank_mask:0xf
v_and_b32_dpp v59, v35, v4 quad_perm:[1,1,1,1] row_mask:0xf bank_mask:0xf
v_add_f32 v8, v8, v20
v_add_f32 v10, v10, v21
v_mfma_f32_16x16x32_bf16 v[24:27], v[80:83], v[56:59], v[24:27]
v_mfma_f32_16x16x32_bf16 v[28:31], v[112:115], v[56:59], v[28:31]
v_and_b32_dpp v60, v36, v4 quad_perm:[1,1,1,1] row_mask:0xf bank_mask:0xf
v_and_b32_dpp v61, v37, v4 quad_perm:[1,1,1,1] row_mask:0xf bank_mask:0xf
v_and_b32_dpp v62, v38, v4 quad_perm:[1,1,1,1] row_mask:0xf bank_mask:0xf
v_and_b32_dpp v63, v39, v4 quad_perm:[1,1,1,1] row_mask:0xf bank_mask:0xf
v_add_f32 v8, v8, v22
v_add_f32 v10, v10, v23
v_mfma_f32_16x16x32_bf16 v[24:27], v[84:87], v[60:63], v[24:27]
v_mfma_f32_16x16x32_bf16 v[28:31], v[116:119], v[60:63], v[28:31]
v_and_b32_dpp v56, v32, v4 quad_perm:[2,2,2,2] row_mask:0xf bank_mask:0xf
v_and_b32_dpp v57, v33, v4 quad_perm:[2,2,2,2] row_mask:0xf bank_mask:0xf
v_and_b32_dpp v58, v34, v4 quad_perm:[2,2,2,2] row_mask:0xf bank_mask:0xf
v_and_b32_dpp v59, v35, v4 quad_perm:[2,2,2,2] row_mask:0xf bank_mask:0xf
v_fmac_f32 v9, v18, v18
v_fmac_f32 v12, v19, v19
v_mfma_f32_16x16x32_bf16 v[24:27], v[88:91], v[56:59], v[24:27]
v_mfma_f32_16x16x32_bf16 v[28:31], v[120:123], v[56:59], v[28:31]
v_and_b32_dpp v60, v36, v4 quad_perm:[2,2,2,2] row_mask:0xf bank_mask:0xf
v_and_b32_dpp v61, v37, v4 quad_perm:[2,2,2,2] row_mask:0xf bank_mask:0xf
v_and_b32_dpp v62, v38, v4 quad_perm:[2,2,2,2] row_mask:0xf bank_mask:0xf
v_and_b32_dpp v63, v39, v4 quad_perm:[2,2,2,2] row_mask:0xf bank_mask:0xf
v_fmac_f32 v9, v20, v20
v_fmac_f32 v12, v21, v21
v_mfma_f32_16x16x32_bf16 v[24:27], v[92:95], v[60:63], v[24:27]
v_mfma_f32_16x16x32_bf16 v[28:31], v[124:127], v[60:63], v[28:31]
v_and_b32_dpp v56, v32, v4 quad_perm:[3,3,3,3] row_mask:0xf bank_mask:0xf
v_and_b32_dpp v57, v33, v4 quad_perm:[3,3,3,3] row_mask:0xf bank_mask:0xf
v_and_b32_dpp v58, v34, v4 quad_perm:[3,3,3,3] row_mask:0xf bank_mask:0xf
v_and_b32_dpp v59, v35, v4 quad_perm:[3,3,3,3] row_mask:0xf bank_mask:0xf
v_fmac_f32 v9, v22, v22
v_fmac_f32 v12, v23, v23
v_mfma_f32_16x16x32_bf16 v[24:27], v[96:99], v[56:59], v[24:27]
v_mfma_f32_16x16x32_bf16 v[28:31], v[128:131], v[56:59], v[28:31]
v_and_b32_dpp v60, v36, v4 quad_perm:[3,3,3,3] row_mask:0xf bank_mask:0xf
v_and_b32_dpp v61, v37, v4 quad_perm:[3,3,3,3] row_mask:0xf bank_mask:0xf
v_and_b32_dpp v62, v38, v4 quad_perm:[3,3,3,3] row_mask:0xf bank_mask:0xf
v_and_b32_dpp v63, v39, v4 quad_perm:[3,3,3,3] row_mask:0xf bank_mask:0xf
v_add_f32 v8, v8, v10
v_add_f32 v9, v9, v12
v_mfma_f32_16x16x32_bf16 v[24:27], v[100:103], v[60:63], v[24:27]
v_mfma_f32_16x16x32_bf16 v[28:31], v[132:135], v[60:63], v[28:31]
s_nop 0
v_add_f32_dpp v8, v8, v8 quad_perm:[1,0,3,2] row_mask:0xf bank_mask:0xf
v_add_f32_dpp v9, v9, v9 quad_perm:[1,0,3,2] row_mask:0xf bank_mask:0xf
s_nop 0
v_add_f32_dpp v8, v8, v8 quad_perm:[2,3,0,1] row_mask:0xf bank_mask:0xf
v_add_f32_dpp v9, v9, v9 quad_perm:[2,3,0,1] row_mask:0xf bank_mask:0xf
s_nop 0
v_mov_b32 v10, v8
v_mov_b32 v12, v9
s_nop 0
v_permlane16_swap_b32 v8, v10
v_permlane16_swap_b32 v9, v12
v_add_f32 v8, v8, v10
v_add_f32 v9, v9, v12
v_mov_b32 v10, v8
v_mov_b32 v12, v9
s_nop 0
v_permlane32_swap_b32 v8, v10
v_permlane32_swap_b32 v9, v12
v_add_f32 v8, v8, v10
v_add_f32 v9, v9, v12
s_mov_b64 exec, 0x1111
ds_write_b64 v11, v[8:9] offset:41216
s_mov_b32 exec_lo, 0x33333333
s_mov_b32 exec_hi, 0x33333333
ds_write_b32 v64, v24 offset:41472
ds_write_b32 v64, v28 offset:43520
ds_write_b32 v64, v25 offset:41504
ds_write_b32 v64, v29 offset:43552
ds_write_b32 v64, v26 offset:41536
ds_write_b32 v64, v30 offset:43584
ds_write_b32 v64, v27 offset:41568
ds_write_b32 v64, v31 offset:43616
s_mov_b64 exec, -1
s_lshl_b32 s57, s100, 2
s_add_u32 s57, s57, s52
s_lshl_b32 s57, s57, 11
s_add_u32 s57, s57, 3145728
s_waitcnt lgkmcnt(0)
s_barrier
ds_read_b128 v[32:35], v13 offset:41216
ds_read_b128 v[36:39], v13 offset:41232
ds_read_b128 v[16:19], v65 offset:41472
ds_read_b128 v[20:23], v65 offset:41488
ds_read_b128 v[24:27], v65 offset:43520
ds_read_b128 v[28:31], v65 offset:43536
s_waitcnt lgkmcnt(4)
v_add_f32 v8, v32, v34
v_add_f32 v10, v36, v38
v_add_f32 v9, v33, v35
v_add_f32 v11, v37, v39
v_add_f32 v8, v8, v10
v_add_f32 v9, v9, v11
v_mul_f32 v8, 0x3b000000, v8
v_mul_f32 v9, 0x3b000000, v9
v_fma_f32 v9, -v8, v8, v9
v_max_f32 v9, 0, v9
v_cvt_pk_bf16_f32 v10, v8, v9
v_lshlrev_b32 v8, 16, v10
v_and_b32 v9, s91, v10
v_add_f32 v9, 0x3727c5ac, v9
v_cvt_pk_bf16_f32 v9, v9, v9
v_and_b32 v9, s91, v9
v_sqrt_f32 v9, v9
s_nop 0
v_cvt_pk_bf16_f32 v9, v9, v9
v_and_b32 v9, s91, v9
v_rcp_f32 v9, v9
s_nop 0
s_waitcnt lgkmcnt(0)
v_add_f32 v16, v16, v17
v_add_f32 v18, v18, v19
v_add_f32 v20, v20, v21
v_add_f32 v22, v22, v23
v_add_f32 v24, v24, v25
v_add_f32 v26, v26, v27
v_add_f32 v28, v28, v29
v_add_f32 v30, v30, v31
v_add_f32 v16, v16, v18
v_add_f32 v20, v20, v22
v_add_f32 v24, v24, v26
v_add_f32 v28, v28, v30
v_fma_f32 v16, -v8, v40, v16
v_fma_f32 v20, -v8, v41, v20
v_fma_f32 v24, -v8, v42, v24
v_fma_f32 v28, -v8, v43, v28
v_fma_f32 v16, v9, v16, v44
v_fma_f32 v20, v9, v20, v45
v_fma_f32 v24, v9, v24, v46
v_fma_f32 v28, v9, v28, v47
v_cvt_pk_bf16_f32 v10, v16, v20
v_lshlrev_b32 v16, 16, v10
v_and_b32 v20, s91, v10
v_cvt_pk_bf16_f32 v11, v24, v28
v_lshlrev_b32 v24, 16, v11
v_and_b32 v28, s91, v11
v_mul_f32 v17, 0xbfb8aa3b, v16
v_mul_f32 v21, 0xbfb8aa3b, v20
v_exp_f32 v17, v17
v_exp_f32 v21, v21
s_nop 0
v_add_f32 v17, 1.0, v17
v_add_f32 v21, 1.0, v21
v_rcp_f32 v17, v17
v_rcp_f32 v21, v21
s_nop 0
v_mul_f32 v16, v16, v17
v_mul_f32 v20, v20, v21
v_cvt_pk_bf16_f32 v10, v16, v20
v_lshlrev_b32 v16, 16, v10
v_and_b32 v20, s91, v10
v_mul_f32 v16, v16, v24
v_mul_f32 v20, v20, v28
v_cvt_pk_bf16_f32 v16, v16, v16
v_cvt_pk_bf16_f32 v17, v20, v20
s_nop 0
v_and_b32_dpp v56, v16, v2 quad_perm:[0,0,0,0] row_mask:0xf bank_mask:0xf
v_and_b32_dpp v57, v16, v3 quad_perm:[0,0,0,0] row_mask:0xf bank_mask:0xf
v_and_b32_dpp v58, v17, v2 quad_perm:[0,0,0,0] row_mask:0xf bank_mask:0xf
v_and_b32_dpp v59, v17, v3 quad_perm:[0,0,0,0] row_mask:0xf bank_mask:0xf
v_and_b32_dpp v60, v16, v2 quad_perm:[1,1,1,1] row_mask:0xf bank_mask:0xf
v_and_b32_dpp v61, v16, v3 quad_perm:[1,1,1,1] row_mask:0xf bank_mask:0xf
v_and_b32_dpp v62, v17, v2 quad_perm:[1,1,1,1] row_mask:0xf bank_mask:0xf
v_and_b32_dpp v63, v17, v3 quad_perm:[1,1,1,1] row_mask:0xf bank_mask:0xf
v_and_b32_dpp v64, v16, v2 quad_perm:[2,2,2,2] row_mask:0xf bank_mask:0xf
v_and_b32_dpp v65, v16, v3 quad_perm:[2,2,2,2] row_mask:0xf bank_mask:0xf
v_and_b32_dpp v66, v17, v2 quad_perm:[2,2,2,2] row_mask:0xf bank_mask:0xf
v_and_b32_dpp v67, v17, v3 quad_perm:[2,2,2,2] row_mask:0xf bank_mask:0xf
v_and_b32_dpp v68, v16, v2 quad_perm:[3,3,3,3] row_mask:0xf bank_mask:0xf
v_and_b32_dpp v69, v16, v3 quad_perm:[3,3,3,3] row_mask:0xf bank_mask:0xf
v_and_b32_dpp v70, v17, v2 quad_perm:[3,3,3,3] row_mask:0xf bank_mask:0xf
v_and_b32_dpp v71, v17, v3 quad_perm:[3,3,3,3] row_mask:0xf bank_mask:0xf
s_nop 1
v_mfma_f32_16x16x16_bf16 v[20:23], v[136:137], v[56:57], 0
v_mfma_f32_16x16x16_bf16 v[24:27], v[138:139], v[56:57], 0
v_mfma_f32_16x16x16_bf16 v[28:31], v[140:141], v[58:59], 0
v_mfma_f32_16x16x16_bf16 v[32:35], v[142:143], v[58:59], 0
v_mfma_f32_16x16x16_bf16 v[20:23], v[144:145], v[60:61], v[20:23]
v_mfma_f32_16x16x16_bf16 v[24:27], v[146:147], v[60:61], v[24:27]
v_mfma_f32_16x16x16_bf16 v[28:31], v[148:149], v[62:63], v[28:31]
v_mfma_f32_16x16x16_bf16 v[32:35], v[150:151], v[62:63], v[32:35]
v_mfma_f32_16x16x16_bf16 v[20:23], v[152:153], v[64:65], v[20:23]
v_mfma_f32_16x16x16_bf16 v[24:27], v[154:155], v[64:65], v[24:27]
v_mfma_f32_16x16x16_bf16 v[28:31], v[156:157], v[66:67], v[28:31]
v_mfma_f32_16x16x16_bf16 v[32:35], v[158:159], v[66:67], v[32:35]
v_mfma_f32_16x16x16_bf16 v[20:23], v[160:161], v[68:69], v[20:23]
v_mfma_f32_16x16x16_bf16 v[24:27], v[162:163], v[68:69], v[24:27]
v_mfma_f32_16x16x16_bf16 v[28:31], v[164:165], v[70:71], v[28:31]
v_mfma_f32_16x16x16_bf16 v[32:35], v[166:167], v[70:71], v[32:35]
s_nop 7
v_add_f32 v20, v20, v28
v_add_f32 v21, v21, v29
v_add_f32 v22, v22, v30
v_add_f32 v23, v23, v31
v_add_f32 v24, v24, v32
v_add_f32 v25, v25, v33
v_add_f32 v26, v26, v34
v_add_f32 v27, v27, v35
v_and_or_b32 v20, v20, -16, s94
v_and_or_b32 v21, v21, -16, s94
v_and_or_b32 v22, v22, -16, s94
v_and_or_b32 v23, v23, -16, s94
buffer_store_dwordx4 v[20:23], v15, s[12:15], s57 offen sc1
v_and_or_b32 v24, v24, -16, s94
v_and_or_b32 v25, v25, -16, s94
v_and_or_b32 v26, v26, -16, s94
v_and_or_b32 v27, v27, -16, s94
buffer_store_dwordx4 v[24:27], v15, s[12:15], s57 offen offset:1024 sc1
s_endpgm
L_s_r:
s_cmp_lg_u32 s52, 2
s_cbranch_scc1 L_end
s_lshr_b32 s100, s2, 3
s_lshl_b32 s100, s100, 5
s_bfe_u32 s57, s2, 0x10002
s_lshl_b32 s57, s57, 2
s_add_u32 s100, s100, s57
s_and_b32 s57, s2, 3
s_lshl_b32 s58, s57, 9
s_add_u32 s58, s58, s100
s_mul_i32 s57, s57, 3072
s_add_u32 s100, s100, s57
v_lshl_add_u32 v11, v5, 3, v7
v_add_u32 v43, s58, v11
v_lshlrev_b32 v10, 1, v43
buffer_load_ushort v42, v10, s[40:43], 0 offen
v_add_u32 v12, s100, v11
v_lshlrev_b32 v12, 2, v12
s_mov_b32 s54, 8192
s_mov_b32 s97, 14336
s_mov_b32 s55, 0
L_poll_32:
buffer_load_dword v40, v12, s[12:15], s54 offen sc1
buffer_load_dword v41, v12, s[12:15], s97 offen sc1
s_waitcnt vmcnt(0)
v_bitop3_b32 v8, v40, v41, v41 bitop3:0x80
v_or3_b32 v9, v40, v41, v41
v_xor_b32 v8, v8, v1
v_xor_b32 v9, v9, v1
v_or_b32 v8, v8, v9
v_and_b32 v8, 0xffff, v8
v_cmp_ne_u32 vcc, 0, v8
s_add_u32 s55, s55, 1
s_cmp_lt_u32 s55, 4000
s_cbranch_scc0 L_pd_33
s_cbranch_vccnz L_poll_32
L_pd_33:
v_and_b32 v40, s91, v40
v_and_b32 v41, s91, v41
v_lshlrev_b32 v42, 16, v42
s_lshr_b32 s101, s2, 5
s_lshl_b32 s101, s101, 11
s_bfe_u32 s57, s2, 0x10002
s_lshl_b32 s57, s57, 10
s_add_u32 s101, s101, s57
s_bfe_u32 s57, s2, 0x20003
s_lshl_b32 s57, s57, 8
s_add_u32 s101, s101, s57
s_and_b32 s57, s2, 3
s_lshl_b32 s57, s57, 6
s_add_u32 s101, s101, s57
v_lshrrev_b32 v12, 2, v0
v_lshlrev_b32 v12, 13, v12
v_lshl_add_u32 v12, v7, 4, v12
v_and_b32 v13, 0xffff, v12
s_add_u32 s54, s101, 2097152
s_add_u32 s97, s101, 2228224
s_add_u32 s98, s101, 2359296
s_add_u32 s99, s101, 2490368
v_lshl_add_u32 v44, v5, 2, v7
v_lshlrev_b32 v44, 2, v44
s_and_b32 s96, s2, 3
s_lshl_b32 s96, s96, 11
s_lshr_b32 s58, s2, 3
s_lshl_b32 s58, s58, 7
s_add_u32 s96, s96, s58
s_bfe_u32 s58, s2, 0x10002
s_lshl_b32 s58, s58, 6
s_add_u32 s96, s96, s58
s_add_u32 s96, s96, 2621440
s_mov_b32 s55, 0
L_p3_34:
buffer_load_dwordx4 v[72:75], v12, s[12:15], s54 offen sc1
buffer_load_dwordx4 v[76:79], v12, s[12:15], s97 offen sc1
buffer_load_dwordx4 v[80:83], v12, s[12:15], s98 offen sc1
buffer_load_dwordx4 v[84:87], v12, s[12:15], s99 offen sc1
s_waitcnt vmcnt(0)
v_bitop3_b32 v8, v72, v73, v74 bitop3:0x80
v_or3_b32 v9, v72, v73, v74
v_bitop3_b32 v8, v8, v75, v76 bitop3:0x80
v_or3_b32 v9, v9, v75, v76
v_bitop3_b32 v8, v8, v77, v78 bitop3:0x80
v_or3_b32 v9, v9, v77, v78
v_bitop3_b32 v8, v8, v79, v80 bitop3:0x80
v_or3_b32 v9, v9, v79, v80
v_bitop3_b32 v8, v8, v81, v82 bitop3:0x80
v_or3_b32 v9, v9, v81, v82
v_bitop3_b32 v8, v8, v83, v84 bitop3:0x80
v_or3_b32 v9, v9, v83, v84
v_bitop3_b32 v8, v8, v85, v86 bitop3:0x80
v_or3_b32 v9, v9, v85, v86
v_bitop3_b32 v8, v8, v87, v87 bitop3:0x80
v_or3_b32 v9, v9, v87, v87
v_bitop3_b32 v8, v8, v9, v1 bitop3:0x7e
v_lshlrev_b32 v8, 28, v8
s_nop 1
v_or_b32_dpp v8, v8, v8 quad_perm:[1,0,3,2] row_mask:0xf bank_mask:0xf
s_nop 1
v_or_b32_dpp v8, v8, v8 quad_perm:[2,3,0,1] row_mask:0xf bank_mask:0xf
v_cmp_ne_u32 vcc, 0, v8
s_add_u32 s55, s55, 1
s_mov_b64 exec, vcc
s_cbranch_execz L_p3d_35
s_cmp_lt_u32 s55, 4000
s_cbranch_scc1 L_p3_34
L_p3d_35:
s_mov_b64 exec, -1
v_add_f32 v72, v72, v76
v_add_f32 v73, v73, v77
v_add_f32 v74, v74, v78
v_add_f32 v75, v75, v79
v_add_f32 v80, v80, v84
v_add_f32 v81, v81, v85
v_add_f32 v82, v82, v86
v_add_f32 v83, v83, v87
v_add_f32 v72, v72, v80
v_add_f32 v73, v73, v81
v_add_f32 v74, v74, v82
v_add_f32 v75, v75, v83
s_nop 1
v_permlane32_swap_b32 v72, v74
v_permlane32_swap_b32 v73, v75
v_add_f32 v72, v72, v74
v_add_f32 v73, v73, v75
s_nop 1
v_permlane16_swap_b32 v72, v73
v_add_f32 v72, v72, v73
s_nop 1
v_add_f32_dpp v72, v72, v72 row_ror:8 row_mask:0xf bank_mask:0xf
s_nop 1
v_add_f32_dpp v72, v72, v72 row_ror:4 row_mask:0xf bank_mask:0xf
v_cvt_pk_bf16_f32 v72, v72, v72
v_and_b32 v72, s91, v72
v_mul_f32 v72, v40, v72
v_cvt_pk_bf16_f32 v72, v72, v72
v_and_b32 v72, s91, v72
v_add_f32 v42, v42, v72
v_cvt_pk_bf16_f32 v42, v42, v42
v_lshl_or_b32 v72, v42, 16, v1
s_mov_b32 exec_lo, 0x000f000f
s_mov_b32 exec_hi, 0x000f000f
buffer_store_dword v72, v44, s[12:15], s96 offen sc1
s_mov_b64 exec, -1
v_and_b32 v42, s91, v42
v_lshlrev_b32 v43, 1, v43
s_add_u32 s54, s101, 3145728
s_add_u32 s97, s101, 3276800
s_add_u32 s98, s101, 3407872
s_add_u32 s99, s101, 3538944
s_mov_b32 s55, 0
L_p3_36:
buffer_load_dwordx4 v[72:75], v12, s[12:15], s54 offen sc1
buffer_load_dwordx4 v[76:79], v12, s[12:15], s97 offen sc1
buffer_load_dwordx4 v[80:83], v12, s[12:15], s98 offen sc1
buffer_load_dwordx4 v[84:87], v13, s[12:15], s99 offen sc1
s_waitcnt vmcnt(0)
v_bitop3_b32 v8, v72, v73, v74 bitop3:0x80
v_or3_b32 v9, v72, v73, v74
v_bitop3_b32 v8, v8, v75, v76 bitop3:0x80
v_or3_b32 v9, v9, v75, v76
v_bitop3_b32 v8, v8, v77, v78 bitop3:0x80
v_or3_b32 v9, v9, v77, v78
v_bitop3_b32 v8, v8, v79, v80 bitop3:0x80
v_or3_b32 v9, v9, v79, v80
v_bitop3_b32 v8, v8, v81, v82 bitop3:0x80
v_or3_b32 v9, v9, v81, v82
v_bitop3_b32 v8, v8, v83, v84 bitop3:0x80
v_or3_b32 v9, v9, v83, v84
v_bitop3_b32 v8, v8, v85, v86 bitop3:0x80
v_or3_b32 v9, v9, v85, v86
v_bitop3_b32 v8, v8, v87, v87 bitop3:0x80
v_or3_b32 v9, v9, v87, v87
v_bitop3_b32 v8, v8, v9, v1 bitop3:0x7e
v_lshlrev_b32 v8, 28, v8
s_nop 1
v_or_b32_dpp v8, v8, v8 quad_perm:[1,0,3,2] row_mask:0xf bank_mask:0xf
s_nop 1
v_or_b32_dpp v8, v8, v8 quad_perm:[2,3,0,1] row_mask:0xf bank_mask:0xf
v_cmp_ne_u32 vcc, 0, v8
s_add_u32 s55, s55, 1
s_mov_b64 exec, vcc
s_cbranch_execz L_p3d_37
s_cmp_lt_u32 s55, 4000
s_cbranch_scc1 L_p3_36
L_p3d_37:
s_mov_b64 exec, -1
v_add_f32 v72, v72, v76
v_add_f32 v73, v73, v77
v_add_f32 v74, v74, v78
v_add_f32 v75, v75, v79
s_mov_b32 exec_hi, 0
v_add_f32 v80, v80, v84
v_add_f32 v81, v81, v85
v_add_f32 v82, v82, v86
v_add_f32 v83, v83, v87
s_mov_b32 exec_hi, -1
v_add_f32 v72, v72, v80
v_add_f32 v73, v73, v81
v_add_f32 v74, v74, v82
v_add_f32 v75, v75, v83
s_nop 1
v_permlane32_swap_b32 v72, v74
v_permlane32_swap_b32 v73, v75
v_add_f32 v72, v72, v74
v_add_f32 v73, v73, v75
s_nop 1
v_permlane16_swap_b32 v72, v73
v_add_f32 v72, v72, v73
s_nop 1
v_add_f32_dpp v72, v72, v72 row_ror:8 row_mask:0xf bank_mask:0xf
s_nop 1
v_add_f32_dpp v72, v72, v72 row_ror:4 row_mask:0xf bank_mask:0xf
v_cvt_pk_bf16_f32 v72, v72, v72
v_and_b32 v72, s91, v72
v_mul_f32 v72, v41, v72
v_cvt_pk_bf16_f32 v72, v72, v72
v_and_b32 v72, s91, v72
v_add_f32 v72, v42, v72
v_cvt_pk_bf16_f32 v72, v72, v72
s_mov_b32 exec_lo, 0x000f000f
s_mov_b32 exec_hi, 0x000f000f
buffer_store_short v72, v43, s[48:51], 0 offen
s_mov_b64 exec, -1
s_cmp_lg_u32 s2, 0
s_cbranch_scc1 L_end
v_mov_b32 v10, s59
v_mov_b32 v11, 0
s_mov_b64 exec, 1
buffer_store_dword v10, v11, s[12:15], 0 offen sc1
s_endpgm
L_kv:
s_mov_b32 s4, s66
s_mov_b32 s5, s67
s_mov_b32 s6, 33554432
s_mov_b32 s7, 0x00020000
s_mov_b32 s8, s68
s_mov_b32 s9, s69
s_mov_b32 s10, 33554432
s_mov_b32 s11, 0x00020000
s_sub_u32 s56, s52, 4
s_and_b32 s84, s2, 7
s_lshl_b32 s84, s84, 2
s_bfe_u32 s57, s2, 0x20003
s_add_u32 s84, s84, s57
s_lshr_b32 s85, s2, 5
v_and_b32 v6, 3, v0
v_lshlrev_b32 v6, 4, v6
v_bfe_u32 v7, v0, 2, 2
v_lshl_add_u32 v6, v7, 8, v6
v_lshrrev_b32 v7, 4, v0
v_lshl_add_u32 v6, v7, 6, v6
v_lshlrev_b32 v8, 4, v0
s_mov_b32 s80, 4096
s_mov_b32 s81, 8192
s_mov_b32 s82, 12288
s_mov_b32 s83, 16384
s_lshl_b32 s57, s84, 20
s_cmp_ge_u32 s85, 6
s_cbranch_scc1 L_kvc_h
s_cmp_ge_u32 s85, 4
s_cbranch_scc1 L_kvc_m
L_kvc_f:
s_mul_i32 s58, s85, 528
s_lshl_b32 s58, s58, 8
s_add_u32 s57, s57, s58
s_mul_i32 s58, s56, 20480
s_cmp_lt_u32 s56, 1
s_cbranch_scc0 L_kvl_38
s_add_u32 s57, s57, s58
s_branch L_kvp_f5
L_kvl_38:
s_mul_i32 s58, s56, 16384
s_add_u32 s57, s57, s58
s_add_u32 s57, s57, 4096
s_branch L_kvp_f4
L_kvc_m:
s_mul_i32 s58, s85, 480
s_add_u32 s58, s58, 192
s_lshl_b32 s58, s58, 8
s_add_u32 s57, s57, s58
s_mul_i32 s58, s56, 16384
s_cmp_lt_u32 s56, 6
s_cbranch_scc0 L_kvl_39
s_add_u32 s57, s57, s58
s_branch L_kvp_n4
L_kvl_39:
s_mul_i32 s58, s56, 12288
s_add_u32 s57, s57, s58
s_add_u32 s57, s57, 24576
s_branch L_kvp_n3
L_kvc_h:
s_mul_i32 s58, s85, 512
s_lshl_b32 s58, s58, 8
s_add_u32 s57, s57, s58
s_mul_i32 s58, s56, 16384
s_add_u32 s57, s57, s58
s_branch L_kvp_n4
L_kvp_f5:
v_add_u32 v1, s57, v6
v_add_u32 v2, s57, v8
buffer_load_dwordx4 v[40:43], v1, s[4:7], 0 offen offset:0 nt
buffer_load_dwordx4 v[44:47], v1, s[4:7], 0 offen offset:1024 nt
s_barrier
v_mov_b32 v6, 41352
s_waitcnt vmcnt(2)
ds_read_b32 v7, v6
s_waitcnt lgkmcnt(0)
v_readfirstlane_b32 s57, v7
s_cmp_ge_u32 s57, 4
s_cbranch_scc1 L_kvf_43
buffer_load_dwordx4 v[48:51], v1, s[4:7], 0 offen offset:2048 nt
s_waitcnt vmcnt(2)
ds_read_b32 v7, v6
s_waitcnt lgkmcnt(0)
v_readfirstlane_b32 s57, v7
s_cmp_ge_u32 s57, 4
s_cbranch_scc1 L_kvf_44
buffer_load_dwordx4 v[52:55], v1, s[4:7], 0 offen offset:3072 nt
s_waitcnt vmcnt(2)
ds_read_b32 v7, v6
s_waitcnt lgkmcnt(0)
v_readfirstlane_b32 s57, v7
s_cmp_ge_u32 s57, 4
s_cbranch_scc1 L_kvf_45
buffer_load_dwordx4 v[56:59], v1, s[4:7], s80 offen offset:0 nt
s_waitcnt vmcnt(2)
ds_read_b32 v7, v6
s_waitcnt lgkmcnt(0)
v_readfirstlane_b32 s57, v7
s_cmp_ge_u32 s57, 4
s_cbranch_scc1 L_kvf_46
buffer_load_dwordx4 v[60:63], v1, s[4:7], s80 offen offset:1024 nt
s_waitcnt vmcnt(2)
ds_read_b32 v7, v6
s_waitcnt lgkmcnt(0)
v_readfirstlane_b32 s57, v7
s_cmp_ge_u32 s57, 4
s_cbranch_scc1 L_kvf_47
buffer_load_dwordx4 v[64:67], v1, s[4:7], s80 offen offset:2048 nt
s_waitcnt vmcnt(2)
ds_read_b32 v7, v6
s_waitcnt lgkmcnt(0)
v_readfirstlane_b32 s57, v7
s_cmp_ge_u32 s57, 4
s_cbranch_scc1 L_kvf_48
buffer_load_dwordx4 v[68:71], v1, s[4:7], s80 offen offset:3072 nt
s_waitcnt vmcnt(2)
ds_read_b32 v7, v6
s_waitcnt lgkmcnt(0)
v_readfirstlane_b32 s57, v7
s_cmp_ge_u32 s57, 4
s_cbranch_scc1 L_kvf_49
buffer_load_dwordx4 v[72:75], v1, s[4:7], s81 offen offset:0 nt
s_waitcnt vmcnt(2)
ds_read_b32 v7, v6
s_waitcnt lgkmcnt(0)
v_readfirstlane_b32 s57, v7
s_cmp_ge_u32 s57, 4
s_cbranch_scc1 L_kvf_50
buffer_load_dwordx4 v[76:79], v1, s[4:7], s81 offen offset:1024 nt
s_waitcnt vmcnt(2)
ds_read_b32 v7, v6
s_waitcnt lgkmcnt(0)
v_readfirstlane_b32 s57, v7
s_cmp_ge_u32 s57, 4
s_cbranch_scc1 L_kvf_51
buffer_load_dwordx4 v[80:83], v1, s[4:7], s81 offen offset:2048 nt
s_waitcnt vmcnt(2)
ds_read_b32 v7, v6
s_waitcnt lgkmcnt(0)
v_readfirstlane_b32 s57, v7
s_cmp_ge_u32 s57, 4
s_cbranch_scc1 L_kvf_52
buffer_load_dwordx4 v[84:87], v1, s[4:7], s81 offen offset:3072 nt
s_waitcnt vmcnt(2)
ds_read_b32 v7, v6
s_waitcnt lgkmcnt(0)
v_readfirstlane_b32 s57, v7
s_cmp_ge_u32 s57, 4
s_cbranch_scc1 L_kvf_53
buffer_load_dwordx4 v[88:91], v1, s[4:7], s82 offen offset:0 nt
s_waitcnt vmcnt(2)
ds_read_b32 v7, v6
s_waitcnt lgkmcnt(0)
v_readfirstlane_b32 s57, v7
s_cmp_ge_u32 s57, 4
s_cbranch_scc1 L_kvf_54
buffer_load_dwordx4 v[92:95], v1, s[4:7], s82 offen offset:1024 nt
s_waitcnt vmcnt(2)
ds_read_b32 v7, v6
s_waitcnt lgkmcnt(0)
v_readfirstlane_b32 s57, v7
s_cmp_ge_u32 s57, 4
s_cbranch_scc1 L_kvf_55
buffer_load_dwordx4 v[96:99], v1, s[4:7], s82 offen offset:2048 nt
s_waitcnt vmcnt(2)
ds_read_b32 v7, v6
s_waitcnt lgkmcnt(0)
v_readfirstlane_b32 s57, v7
s_cmp_ge_u32 s57, 4
s_cbranch_scc1 L_kvf_56
buffer_load_dwordx4 v[100:103], v1, s[4:7], s82 offen offset:3072 nt
s_waitcnt vmcnt(2)
ds_read_b32 v7, v6
s_waitcnt lgkmcnt(0)
v_readfirstlane_b32 s57, v7
s_cmp_ge_u32 s57, 4
s_cbranch_scc1 L_kvf_57
buffer_load_dwordx4 v[104:107], v1, s[4:7], s83 offen offset:0 nt
s_waitcnt vmcnt(2)
ds_read_b32 v7, v6
s_waitcnt lgkmcnt(0)
v_readfirstlane_b32 s57, v7
s_cmp_ge_u32 s57, 4
s_cbranch_scc1 L_kvf_58
buffer_load_dwordx4 v[108:111], v1, s[4:7], s83 offen offset:1024 nt
s_waitcnt vmcnt(2)
ds_read_b32 v7, v6
s_waitcnt lgkmcnt(0)
v_readfirstlane_b32 s57, v7
s_cmp_ge_u32 s57, 4
s_cbranch_scc1 L_kvf_59
buffer_load_dwordx4 v[112:115], v1, s[4:7], s83 offen offset:2048 nt
s_waitcnt vmcnt(2)
ds_read_b32 v7, v6
s_waitcnt lgkmcnt(0)
v_readfirstlane_b32 s57, v7
s_cmp_ge_u32 s57, 4
s_cbranch_scc1 L_kvf_60
buffer_load_dwordx4 v[116:119], v1, s[4:7], s83 offen offset:3072 nt
s_waitcnt vmcnt(2)
ds_read_b32 v7, v6
s_waitcnt lgkmcnt(0)
v_readfirstlane_b32 s57, v7
s_cmp_ge_u32 s57, 4
s_cbranch_scc1 L_kvf_61
buffer_load_dwordx4 v[120:123], v2, s[8:11], 0 offen offset:0 nt
s_waitcnt vmcnt(2)
ds_read_b32 v7, v6
s_waitcnt lgkmcnt(0)
v_readfirstlane_b32 s57, v7
s_cmp_ge_u32 s57, 4
s_cbranch_scc1 L_kvf_62
buffer_load_dwordx4 v[124:127], v2, s[8:11], 0 offen offset:1024 nt
s_waitcnt vmcnt(2)
ds_read_b32 v7, v6
s_waitcnt lgkmcnt(0)
v_readfirstlane_b32 s57, v7
s_cmp_ge_u32 s57, 4
s_cbranch_scc1 L_kvf_63
buffer_load_dwordx4 v[128:131], v2, s[8:11], 0 offen offset:2048 nt
s_waitcnt vmcnt(2)
ds_read_b32 v7, v6
s_waitcnt lgkmcnt(0)
v_readfirstlane_b32 s57, v7
s_cmp_ge_u32 s57, 4
s_cbranch_scc1 L_kvf_64
buffer_load_dwordx4 v[132:135], v2, s[8:11], 0 offen offset:3072 nt
s_waitcnt vmcnt(2)
ds_read_b32 v7, v6
s_waitcnt lgkmcnt(0)
v_readfirstlane_b32 s57, v7
s_cmp_ge_u32 s57, 4
s_cbranch_scc1 L_kvf_65
buffer_load_dwordx4 v[136:139], v2, s[8:11], s80 offen offset:0 nt
s_waitcnt vmcnt(2)
ds_read_b32 v7, v6
s_waitcnt lgkmcnt(0)
v_readfirstlane_b32 s57, v7
s_cmp_ge_u32 s57, 4
s_cbranch_scc1 L_kvf_66
buffer_load_dwordx4 v[140:143], v2, s[8:11], s80 offen offset:1024 nt
s_waitcnt vmcnt(2)
ds_read_b32 v7, v6
s_waitcnt lgkmcnt(0)
v_readfirstlane_b32 s57, v7
s_cmp_ge_u32 s57, 4
s_cbranch_scc1 L_kvf_67
buffer_load_dwordx4 v[144:147], v2, s[8:11], s80 offen offset:2048 nt
s_waitcnt vmcnt(2)
ds_read_b32 v7, v6
s_waitcnt lgkmcnt(0)
v_readfirstlane_b32 s57, v7
s_cmp_ge_u32 s57, 4
s_cbranch_scc1 L_kvf_68
buffer_load_dwordx4 v[148:151], v2, s[8:11], s80 offen offset:3072 nt
s_waitcnt vmcnt(2)
ds_read_b32 v7, v6
s_waitcnt lgkmcnt(0)
v_readfirstlane_b32 s57, v7
s_cmp_ge_u32 s57, 4
s_cbranch_scc1 L_kvf_69
buffer_load_dwordx4 v[152:155], v2, s[8:11], s81 offen offset:0 nt
s_waitcnt vmcnt(2)
ds_read_b32 v7, v6
s_waitcnt lgkmcnt(0)
v_readfirstlane_b32 s57, v7
s_cmp_ge_u32 s57, 4
s_cbranch_scc1 L_kvf_70
buffer_load_dwordx4 v[156:159], v2, s[8:11], s81 offen offset:1024 nt
s_waitcnt vmcnt(2)
ds_read_b32 v7, v6
s_waitcnt lgkmcnt(0)
v_readfirstlane_b32 s57, v7
s_cmp_ge_u32 s57, 4
s_cbranch_scc1 L_kvf_71
buffer_load_dwordx4 v[160:163], v2, s[8:11], s81 offen offset:2048 nt
s_waitcnt vmcnt(2)
ds_read_b32 v7, v6
s_waitcnt lgkmcnt(0)
v_readfirstlane_b32 s57, v7
s_cmp_ge_u32 s57, 4
s_cbranch_scc1 L_kvf_72
buffer_load_dwordx4 v[164:167], v2, s[8:11], s81 offen offset:3072 nt
s_branch L_kvall_40
L_kvf_43:
buffer_load_dwordx4 v[48:51], v1, s[4:7], 0 offen offset:2048 nt
L_kvf_44:
buffer_load_dwordx4 v[52:55], v1, s[4:7], 0 offen offset:3072 nt
L_kvf_45:
buffer_load_dwordx4 v[56:59], v1, s[4:7], s80 offen offset:0 nt
L_kvf_46:
buffer_load_dwordx4 v[60:63], v1, s[4:7], s80 offen offset:1024 nt
L_kvf_47:
buffer_load_dwordx4 v[64:67], v1, s[4:7], s80 offen offset:2048 nt
L_kvf_48:
buffer_load_dwordx4 v[68:71], v1, s[4:7], s80 offen offset:3072 nt
L_kvf_49:
buffer_load_dwordx4 v[72:75], v1, s[4:7], s81 offen offset:0 nt
L_kvf_50:
buffer_load_dwordx4 v[76:79], v1, s[4:7], s81 offen offset:1024 nt
L_kvf_51:
buffer_load_dwordx4 v[80:83], v1, s[4:7], s81 offen offset:2048 nt
L_kvf_52:
buffer_load_dwordx4 v[84:87], v1, s[4:7], s81 offen offset:3072 nt
L_kvf_53:
buffer_load_dwordx4 v[88:91], v1, s[4:7], s82 offen offset:0 nt
L_kvf_54:
buffer_load_dwordx4 v[92:95], v1, s[4:7], s82 offen offset:1024 nt
L_kvf_55:
buffer_load_dwordx4 v[96:99], v1, s[4:7], s82 offen offset:2048 nt
L_kvf_56:
buffer_load_dwordx4 v[100:103], v1, s[4:7], s82 offen offset:3072 nt
L_kvf_57:
buffer_load_dwordx4 v[104:107], v1, s[4:7], s83 offen offset:0 nt
L_kvf_58:
buffer_load_dwordx4 v[108:111], v1, s[4:7], s83 offen offset:1024 nt
L_kvf_59:
buffer_load_dwordx4 v[112:115], v1, s[4:7], s83 offen offset:2048 nt
L_kvf_60:
buffer_load_dwordx4 v[116:119], v1, s[4:7], s83 offen offset:3072 nt
L_kvf_61:
buffer_load_dwordx4 v[120:123], v2, s[8:11], 0 offen offset:0 nt
L_kvf_62:
buffer_load_dwordx4 v[124:127], v2, s[8:11], 0 offen offset:1024 nt
L_kvf_63:
buffer_load_dwordx4 v[128:131], v2, s[8:11], 0 offen offset:2048 nt
L_kvf_64:
buffer_load_dwordx4 v[132:135], v2, s[8:11], 0 offen offset:3072 nt
L_kvf_65:
buffer_load_dwordx4 v[136:139], v2, s[8:11], s80 offen offset:0 nt
L_kvf_66:
buffer_load_dwordx4 v[140:143], v2, s[8:11], s80 offen offset:1024 nt
L_kvf_67:
buffer_load_dwordx4 v[144:147], v2, s[8:11], s80 offen offset:2048 nt
L_kvf_68:
buffer_load_dwordx4 v[148:151], v2, s[8:11], s80 offen offset:3072 nt
L_kvf_69:
buffer_load_dwordx4 v[152:155], v2, s[8:11], s81 offen offset:0 nt
L_kvf_70:
buffer_load_dwordx4 v[156:159], v2, s[8:11], s81 offen offset:1024 nt
L_kvf_71:
buffer_load_dwordx4 v[160:163], v2, s[8:11], s81 offen offset:2048 nt
L_kvf_72:
buffer_load_dwordx4 v[164:167], v2, s[8:11], s81 offen offset:3072 nt
L_kvall_40:
v_mov_b32 v6, 0xffff
v_mov_b32 v4, s91
v_cndmask_b32 v4, v6, v4, s[60:61]
v_mov_b32 v6, 0
v_cndmask_b32 v5, v6, v4, s[62:63]
v_cndmask_b32 v4, v4, v6, s[62:63]
s_waitcnt lgkmcnt(0)
s_add_u32 s59, s59, 1
s_and_b32 s53, s59, 0xffff
s_and_b32 s94, s59, 15
v_mov_b32 v3, s53
v_mov_b32 v6, 41352
s_mov_b32 s55, 0
L_lw_73:
ds_read_b32 v7, v6
s_waitcnt lgkmcnt(0)
v_readfirstlane_b32 s57, v7
s_add_u32 s55, s55, 1
s_cmp_ge_u32 s57, 4
s_cbranch_scc1 L_lwd_74
s_sleep 1
s_cmp_lt_u32 s55, 400000
s_cbranch_scc1 L_lw_73
L_lwd_74:
v_bfe_u32 v6, v0, 2, 2
v_lshlrev_b32 v6, 8, v6
v_lshrrev_b32 v7, 4, v0
v_lshl_add_u32 v6, v7, 6, v6
v_and_b32 v7, 3, v0
v_lshl_add_u32 v6, v7, 4, v6
ds_read_b128 v[12:15], v6 offset:20480
s_waitcnt lgkmcnt(0)
s_waitcnt vmcnt(28)
v_mfma_f32_16x16x32_bf16 v[16:19], v[40:43], v[12:15], 0
v_mfma_f32_16x16x32_bf16 v[20:23], v[44:47], v[12:15], 0
v_mfma_f32_16x16x32_bf16 v[24:27], v[48:51], v[12:15], 0
v_mfma_f32_16x16x32_bf16 v[28:31], v[52:55], v[12:15], 0
s_nop 7
v_cndmask_b32 v16, v16, v17, s[60:61]
v_cndmask_b32 v18, v18, v19, s[60:61]
v_cndmask_b32 v16, v16, v18, s[62:63]
v_cndmask_b32 v20, v20, v21, s[60:61]
v_cndmask_b32 v22, v22, v23, s[60:61]
v_cndmask_b32 v20, v20, v22, s[62:63]
v_cndmask_b32 v24, v24, v25, s[60:61]
v_cndmask_b32 v26, v26, v27, s[60:61]
v_cndmask_b32 v24, v24, v26, s[62:63]
v_cndmask_b32 v28, v28, v29, s[60:61]
v_cndmask_b32 v30, v30, v31, s[60:61]
v_cndmask_b32 v28, v28, v30, s[62:63]
buffer_load_dwordx4 v[40:43], v2, s[8:11], s82 offen offset:0 nt
buffer_load_dwordx4 v[44:47], v2, s[8:11], s82 offen offset:1024 nt
buffer_load_dwordx4 v[48:51], v2, s[8:11], s82 offen offset:2048 nt
buffer_load_dwordx4 v[52:55], v2, s[8:11], s82 offen offset:3072 nt
v_cndmask_b32 v17, v16, v20, s[60:61]
v_cndmask_b32 v18, v20, v16, s[60:61]
v_cndmask_b32 v25, v24, v28, s[60:61]
v_cndmask_b32 v26, v28, v24, s[60:61]
s_nop 0
v_add_f32_dpp v16, v18, v17 quad_perm:[1,0,3,2] row_mask:0xf bank_mask:0xf
v_add_f32_dpp v24, v26, v25 quad_perm:[1,0,3,2] row_mask:0xf bank_mask:0xf
v_cndmask_b32 v17, v16, v24, s[62:63]
v_cndmask_b32 v18, v24, v16, s[62:63]
s_nop 1
v_add_f32_dpp v32, v18, v17 quad_perm:[2,3,0,1] row_mask:0xf bank_mask:0xf
s_waitcnt vmcnt(28)
v_mfma_f32_16x16x32_bf16 v[16:19], v[56:59], v[12:15], 0
v_mfma_f32_16x16x32_bf16 v[20:23], v[60:63], v[12:15], 0
v_mfma_f32_16x16x32_bf16 v[24:27], v[64:67], v[12:15], 0
v_mfma_f32_16x16x32_bf16 v[28:31], v[68:71], v[12:15], 0
s_nop 7
v_cndmask_b32 v16, v16, v17, s[60:61]
v_cndmask_b32 v18, v18, v19, s[60:61]
v_cndmask_b32 v16, v16, v18, s[62:63]
v_cndmask_b32 v20, v20, v21, s[60:61]
v_cndmask_b32 v22, v22, v23, s[60:61]
v_cndmask_b32 v20, v20, v22, s[62:63]
v_cndmask_b32 v24, v24, v25, s[60:61]
v_cndmask_b32 v26, v26, v27, s[60:61]
v_cndmask_b32 v24, v24, v26, s[62:63]
v_cndmask_b32 v28, v28, v29, s[60:61]
v_cndmask_b32 v30, v30, v31, s[60:61]
v_cndmask_b32 v28, v28, v30, s[62:63]
buffer_load_dwordx4 v[56:59], v2, s[8:11], s83 offen offset:0 nt
buffer_load_dwordx4 v[60:63], v2, s[8:11], s83 offen offset:1024 nt
buffer_load_dwordx4 v[64:67], v2, s[8:11], s83 offen offset:2048 nt
buffer_load_dwordx4 v[68:71], v2, s[8:11], s83 offen offset:3072 nt
v_cndmask_b32 v17, v16, v20, s[60:61]
v_cndmask_b32 v18, v20, v16, s[60:61]
v_cndmask_b32 v25, v24, v28, s[60:61]
v_cndmask_b32 v26, v28, v24, s[60:61]
s_nop 0
v_add_f32_dpp v16, v18, v17 quad_perm:[1,0,3,2] row_mask:0xf bank_mask:0xf
v_add_f32_dpp v24, v26, v25 quad_perm:[1,0,3,2] row_mask:0xf bank_mask:0xf
v_cndmask_b32 v17, v16, v24, s[62:63]
v_cndmask_b32 v18, v24, v16, s[62:63]
s_nop 1
v_add_f32_dpp v33, v18, v17 quad_perm:[2,3,0,1] row_mask:0xf bank_mask:0xf
s_waitcnt vmcnt(28)
v_mfma_f32_16x16x32_bf16 v[16:19], v[72:75], v[12:15], 0
v_mfma_f32_16x16x32_bf16 v[20:23], v[76:79], v[12:15], 0
v_mfma_f32_16x16x32_bf16 v[24:27], v[80:83], v[12:15], 0
v_mfma_f32_16x16x32_bf16 v[28:31], v[84:87], v[12:15], 0
s_nop 7
v_cndmask_b32 v16, v16, v17, s[60:61]
v_cndmask_b32 v18, v18, v19, s[60:61]
v_cndmask_b32 v16, v16, v18, s[62:63]
v_cndmask_b32 v20, v20, v21, s[60:61]
v_cndmask_b32 v22, v22, v23, s[60:61]
v_cndmask_b32 v20, v20, v22, s[62:63]
v_cndmask_b32 v24, v24, v25, s[60:61]
v_cndmask_b32 v26, v26, v27, s[60:61]
v_cndmask_b32 v24, v24, v26, s[62:63]
v_cndmask_b32 v28, v28, v29, s[60:61]
v_cndmask_b32 v30, v30, v31, s[60:61]
v_cndmask_b32 v28, v28, v30, s[62:63]
v_cndmask_b32 v17, v16, v20, s[60:61]
v_cndmask_b32 v18, v20, v16, s[60:61]
v_cndmask_b32 v25, v24, v28, s[60:61]
v_cndmask_b32 v26, v28, v24, s[60:61]
s_nop 0
v_add_f32_dpp v16, v18, v17 quad_perm:[1,0,3,2] row_mask:0xf bank_mask:0xf
v_add_f32_dpp v24, v26, v25 quad_perm:[1,0,3,2] row_mask:0xf bank_mask:0xf
v_cndmask_b32 v17, v16, v24, s[62:63]
v_cndmask_b32 v18, v24, v16, s[62:63]
s_nop 1
v_add_f32_dpp v34, v18, v17 quad_perm:[2,3,0,1] row_mask:0xf bank_mask:0xf
s_waitcnt vmcnt(24)
v_mfma_f32_16x16x32_bf16 v[16:19], v[88:91], v[12:15], 0
v_mfma_f32_16x16x32_bf16 v[20:23], v[92:95], v[12:15], 0
v_mfma_f32_16x16x32_bf16 v[24:27], v[96:99], v[12:15], 0
v_mfma_f32_16x16x32_bf16 v[28:31], v[100:103], v[12:15], 0
s_nop 7
v_cndmask_b32 v16, v16, v17, s[60:61]
v_cndmask_b32 v18, v18, v19, s[60:61]
v_cndmask_b32 v16, v16, v18, s[62:63]
v_cndmask_b32 v20, v20, v21, s[60:61]
v_cndmask_b32 v22, v22, v23, s[60:61]
v_cndmask_b32 v20, v20, v22, s[62:63]
v_cndmask_b32 v24, v24, v25, s[60:61]
v_cndmask_b32 v26, v26, v27, s[60:61]
v_cndmask_b32 v24, v24, v26, s[62:63]
v_cndmask_b32 v28, v28, v29, s[60:61]
v_cndmask_b32 v30, v30, v31, s[60:61]
v_cndmask_b32 v28, v28, v30, s[62:63]
v_cndmask_b32 v17, v16, v20, s[60:61]
v_cndmask_b32 v18, v20, v16, s[60:61]
v_cndmask_b32 v25, v24, v28, s[60:61]
v_cndmask_b32 v26, v28, v24, s[60:61]
s_nop 0
v_add_f32_dpp v16, v18, v17 quad_perm:[1,0,3,2] row_mask:0xf bank_mask:0xf
v_add_f32_dpp v24, v26, v25 quad_perm:[1,0,3,2] row_mask:0xf bank_mask:0xf
v_cndmask_b32 v17, v16, v24, s[62:63]
v_cndmask_b32 v18, v24, v16, s[62:63]
s_nop 1
v_add_f32_dpp v35, v18, v17 quad_perm:[2,3,0,1] row_mask:0xf bank_mask:0xf
s_waitcnt vmcnt(20)
v_mfma_f32_16x16x32_bf16 v[16:19], v[104:107], v[12:15], 0
v_mfma_f32_16x16x32_bf16 v[20:23], v[108:111], v[12:15], 0
v_mfma_f32_16x16x32_bf16 v[24:27], v[112:115], v[12:15], 0
v_mfma_f32_16x16x32_bf16 v[28:31], v[116:119], v[12:15], 0
s_nop 7
v_cndmask_b32 v16, v16, v17, s[60:61]
v_cndmask_b32 v18, v18, v19, s[60:61]
v_cndmask_b32 v16, v16, v18, s[62:63]
v_cndmask_b32 v20, v20, v21, s[60:61]
v_cndmask_b32 v22, v22, v23, s[60:61]
v_cndmask_b32 v20, v20, v22, s[62:63]
v_cndmask_b32 v24, v24, v25, s[60:61]
v_cndmask_b32 v26, v26, v27, s[60:61]
v_cndmask_b32 v24, v24, v26, s[62:63]
v_cndmask_b32 v28, v28, v29, s[60:61]
v_cndmask_b32 v30, v30, v31, s[60:61]
v_cndmask_b32 v28, v28, v30, s[62:63]
v_cndmask_b32 v17, v16, v20, s[60:61]
v_cndmask_b32 v18, v20, v16, s[60:61]
v_cndmask_b32 v25, v24, v28, s[60:61]
v_cndmask_b32 v26, v28, v24, s[60:61]
s_nop 0
v_add_f32_dpp v16, v18, v17 quad_perm:[1,0,3,2] row_mask:0xf bank_mask:0xf
v_add_f32_dpp v24, v26, v25 quad_perm:[1,0,3,2] row_mask:0xf bank_mask:0xf
v_cndmask_b32 v17, v16, v24, s[62:63]
v_cndmask_b32 v18, v24, v16, s[62:63]
s_nop 1
v_add_f32_dpp v36, v18, v17 quad_perm:[2,3,0,1] row_mask:0xf bank_mask:0xf
v_cvt_pk_bf16_f32 v6, v32, v33
v_lshlrev_b32 v32, 16, v6
v_and_b32 v33, s91, v6
v_cvt_pk_bf16_f32 v7, v34, v35
v_lshlrev_b32 v34, 16, v7
v_and_b32 v35, s91, v7
v_cvt_pk_bf16_f32 v36, v36, v36
v_and_b32 v36, s91, v36
v_mul_f32 v32, 0x3db504f3, v32
v_mul_f32 v33, 0x3db504f3, v33
v_mul_f32 v34, 0x3db504f3, v34
v_mul_f32 v35, 0x3db504f3, v35
v_mul_f32 v36, 0x3db504f3, v36
v_cvt_pk_bf16_f32 v6, v32, v33
v_lshlrev_b32 v32, 16, v6
v_and_b32 v33, s91, v6
v_cvt_pk_bf16_f32 v7, v34, v35
v_lshlrev_b32 v34, 16, v7
v_and_b32 v35, s91, v7
v_cvt_pk_bf16_f32 v36, v36, v36
v_and_b32 v36, s91, v36
v_max3_f32 v38, v32, v33, v34
v_max3_f32 v38, v38, v35, v36
s_nop 1
v_max_f32_dpp v38, v38, v38 quad_perm:[1,0,3,2] row_mask:0xf bank_mask:0xf
s_nop 1
v_max_f32_dpp v38, v38, v38 quad_perm:[2,3,0,1] row_mask:0xf bank_mask:0xf
v_mov_b32 v6, v38
s_nop 1
v_permlane16_swap_b32 v38, v6
v_max_f32 v38, v38, v6
v_mov_b32 v6, v38
s_nop 1
v_permlane32_swap_b32 v38, v6
v_max_f32 v38, v38, v6
v_sub_f32 v32, v32, v38
v_sub_f32 v33, v33, v38
v_sub_f32 v34, v34, v38
v_sub_f32 v35, v35, v38
v_sub_f32 v36, v36, v38
v_mul_f32 v32, 0x3fb8aa3b, v32
v_mul_f32 v33, 0x3fb8aa3b, v33
v_mul_f32 v34, 0x3fb8aa3b, v34
v_mul_f32 v35, 0x3fb8aa3b, v35
v_mul_f32 v36, 0x3fb8aa3b, v36
v_exp_f32 v32, v32
v_exp_f32 v33, v33
v_exp_f32 v34, v34
v_exp_f32 v35, v35
v_exp_f32 v36, v36
s_nop 0
v_add_f32 v39, v32, v33
v_add_f32 v39, v39, v34
v_add_f32 v39, v39, v35
v_add_f32 v39, v39, v36
v_cvt_pk_bf16_f32 v32, v32, v32
v_cvt_pk_bf16_f32 v33, v33, v33
v_cvt_pk_bf16_f32 v34, v34, v34
v_cvt_pk_bf16_f32 v35, v35, v35
v_cvt_pk_bf16_f32 v36, v36, v36
s_nop 0
v_and_b32_dpp v72, v32, v4 quad_perm:[0,0,0,0] row_mask:0xf bank_mask:0xf
v_and_b32_dpp v73, v32, v5 quad_perm:[0,0,0,0] row_mask:0xf bank_mask:0xf
v_and_b32_dpp v74, v32, v4 quad_perm:[1,1,1,1] row_mask:0xf bank_mask:0xf
v_and_b32_dpp v75, v32, v5 quad_perm:[1,1,1,1] row_mask:0xf bank_mask:0xf
v_and_b32_dpp v76, v32, v4 quad_perm:[2,2,2,2] row_mask:0xf bank_mask:0xf
v_and_b32_dpp v77, v32, v5 quad_perm:[2,2,2,2] row_mask:0xf bank_mask:0xf
v_and_b32_dpp v78, v32, v4 quad_perm:[3,3,3,3] row_mask:0xf bank_mask:0xf
v_and_b32_dpp v79, v32, v5 quad_perm:[3,3,3,3] row_mask:0xf bank_mask:0xf
v_and_b32_dpp v80, v33, v4 quad_perm:[0,0,0,0] row_mask:0xf bank_mask:0xf
v_and_b32_dpp v81, v33, v5 quad_perm:[0,0,0,0] row_mask:0xf bank_mask:0xf
v_and_b32_dpp v82, v33, v4 quad_perm:[1,1,1,1] row_mask:0xf bank_mask:0xf
v_and_b32_dpp v83, v33, v5 quad_perm:[1,1,1,1] row_mask:0xf bank_mask:0xf
v_and_b32_dpp v84, v33, v4 quad_perm:[2,2,2,2] row_mask:0xf bank_mask:0xf
v_and_b32_dpp v85, v33, v5 quad_perm:[2,2,2,2] row_mask:0xf bank_mask:0xf
v_and_b32_dpp v86, v33, v4 quad_perm:[3,3,3,3] row_mask:0xf bank_mask:0xf
v_and_b32_dpp v87, v33, v5 quad_perm:[3,3,3,3] row_mask:0xf bank_mask:0xf
v_and_b32_dpp v88, v34, v4 quad_perm:[0,0,0,0] row_mask:0xf bank_mask:0xf
v_and_b32_dpp v89, v34, v5 quad_perm:[0,0,0,0] row_mask:0xf bank_mask:0xf
v_and_b32_dpp v90, v34, v4 quad_perm:[1,1,1,1] row_mask:0xf bank_mask:0xf
v_and_b32_dpp v91, v34, v5 quad_perm:[1,1,1,1] row_mask:0xf bank_mask:0xf
v_and_b32_dpp v92, v34, v4 quad_perm:[2,2,2,2] row_mask:0xf bank_mask:0xf
v_and_b32_dpp v93, v34, v5 quad_perm:[2,2,2,2] row_mask:0xf bank_mask:0xf
v_and_b32_dpp v94, v34, v4 quad_perm:[3,3,3,3] row_mask:0xf bank_mask:0xf
v_and_b32_dpp v95, v34, v5 quad_perm:[3,3,3,3] row_mask:0xf bank_mask:0xf
v_and_b32_dpp v96, v35, v4 quad_perm:[0,0,0,0] row_mask:0xf bank_mask:0xf
v_and_b32_dpp v97, v35, v5 quad_perm:[0,0,0,0] row_mask:0xf bank_mask:0xf
v_and_b32_dpp v98, v35, v4 quad_perm:[1,1,1,1] row_mask:0xf bank_mask:0xf
v_and_b32_dpp v99, v35, v5 quad_perm:[1,1,1,1] row_mask:0xf bank_mask:0xf
v_and_b32_dpp v100, v35, v4 quad_perm:[2,2,2,2] row_mask:0xf bank_mask:0xf
v_and_b32_dpp v101, v35, v5 quad_perm:[2,2,2,2] row_mask:0xf bank_mask:0xf
v_and_b32_dpp v102, v35, v4 quad_perm:[3,3,3,3] row_mask:0xf bank_mask:0xf
v_and_b32_dpp v103, v35, v5 quad_perm:[3,3,3,3] row_mask:0xf bank_mask:0xf
v_and_b32_dpp v104, v36, v4 quad_perm:[0,0,0,0] row_mask:0xf bank_mask:0xf
v_and_b32_dpp v105, v36, v5 quad_perm:[0,0,0,0] row_mask:0xf bank_mask:0xf
v_and_b32_dpp v106, v36, v4 quad_perm:[1,1,1,1] row_mask:0xf bank_mask:0xf
v_and_b32_dpp v107, v36, v5 quad_perm:[1,1,1,1] row_mask:0xf bank_mask:0xf
v_and_b32_dpp v108, v36, v4 quad_perm:[2,2,2,2] row_mask:0xf bank_mask:0xf
v_and_b32_dpp v109, v36, v5 quad_perm:[2,2,2,2] row_mask:0xf bank_mask:0xf
v_and_b32_dpp v110, v36, v4 quad_perm:[3,3,3,3] row_mask:0xf bank_mask:0xf
v_and_b32_dpp v111, v36, v5 quad_perm:[3,3,3,3] row_mask:0xf bank_mask:0xf
s_nop 1
v_add_f32_dpp v39, v39, v39 quad_perm:[1,0,3,2] row_mask:0xf bank_mask:0xf
s_nop 1
v_add_f32_dpp v39, v39, v39 quad_perm:[2,3,0,1] row_mask:0xf bank_mask:0xf
v_mov_b32 v6, v39
s_nop 1
v_permlane16_swap_b32 v39, v6
v_add_f32 v39, v39, v6
v_mov_b32 v6, v39
s_nop 1
v_permlane32_swap_b32 v39, v6
v_add_f32 v39, v39, v6
v_bfe_u32 v6, v0, 2, 2
v_lshlrev_b32 v6, 6, v6
s_lshl_b32 s57, s56, 3
v_add_u32 v6, s57, v6
s_mov_b64 exec, 0x1111
ds_write_b32 v6, v38 offset:40960
ds_write_b32 v6, v39 offset:40964
s_mov_b64 exec, -1
s_waitcnt vmcnt(19)
v_mfma_f32_16x16x16_bf16 v[112:115], v[120:121], v[72:73], 0
v_mfma_f32_16x16x16_bf16 v[116:119], v[122:123], v[72:73], 0
s_waitcnt vmcnt(18)
v_mfma_f32_16x16x16_bf16 v[112:115], v[124:125], v[74:75], v[112:115]
v_mfma_f32_16x16x16_bf16 v[116:119], v[126:127], v[74:75], v[116:119]
s_waitcnt vmcnt(17)
v_mfma_f32_16x16x16_bf16 v[112:115], v[128:129], v[76:77], v[112:115]
v_mfma_f32_16x16x16_bf16 v[116:119], v[130:131], v[76:77], v[116:119]
s_waitcnt vmcnt(16)
v_mfma_f32_16x16x16_bf16 v[112:115], v[132:133], v[78:79], v[112:115]
v_mfma_f32_16x16x16_bf16 v[116:119], v[134:135], v[78:79], v[116:119]
s_waitcnt vmcnt(15)
v_mfma_f32_16x16x16_bf16 v[112:115], v[136:137], v[80:81], v[112:115]
v_mfma_f32_16x16x16_bf16 v[116:119], v[138:139], v[80:81], v[116:119]
s_waitcnt vmcnt(14)
v_mfma_f32_16x16x16_bf16 v[112:115], v[140:141], v[82:83], v[112:115]
v_mfma_f32_16x16x16_bf16 v[116:119], v[142:143], v[82:83], v[116:119]
s_waitcnt vmcnt(13)
v_mfma_f32_16x16x16_bf16 v[112:115], v[144:145], v[84:85], v[112:115]
v_mfma_f32_16x16x16_bf16 v[116:119], v[146:147], v[84:85], v[116:119]
s_waitcnt vmcnt(12)
v_mfma_f32_16x16x16_bf16 v[112:115], v[148:149], v[86:87], v[112:115]
v_mfma_f32_16x16x16_bf16 v[116:119], v[150:151], v[86:87], v[116:119]
s_waitcnt vmcnt(11)
v_mfma_f32_16x16x16_bf16 v[112:115], v[152:153], v[88:89], v[112:115]
v_mfma_f32_16x16x16_bf16 v[116:119], v[154:155], v[88:89], v[116:119]
s_waitcnt vmcnt(10)
v_mfma_f32_16x16x16_bf16 v[112:115], v[156:157], v[90:91], v[112:115]
v_mfma_f32_16x16x16_bf16 v[116:119], v[158:159], v[90:91], v[116:119]
s_waitcnt vmcnt(9)
v_mfma_f32_16x16x16_bf16 v[112:115], v[160:161], v[92:93], v[112:115]
v_mfma_f32_16x16x16_bf16 v[116:119], v[162:163], v[92:93], v[116:119]
s_waitcnt vmcnt(8)
v_mfma_f32_16x16x16_bf16 v[112:115], v[164:165], v[94:95], v[112:115]
v_mfma_f32_16x16x16_bf16 v[116:119], v[166:167], v[94:95], v[116:119]
s_waitcnt vmcnt(7)
v_mfma_f32_16x16x16_bf16 v[112:115], v[40:41], v[96:97], v[112:115]
v_mfma_f32_16x16x16_bf16 v[116:119], v[42:43], v[96:97], v[116:119]
s_waitcnt vmcnt(6)
v_mfma_f32_16x16x16_bf16 v[112:115], v[44:45], v[98:99], v[112:115]
v_mfma_f32_16x16x16_bf16 v[116:119], v[46:47], v[98:99], v[116:119]
s_waitcnt vmcnt(5)
v_mfma_f32_16x16x16_bf16 v[112:115], v[48:49], v[100:101], v[112:115]
v_mfma_f32_16x16x16_bf16 v[116:119], v[50:51], v[100:101], v[116:119]
s_waitcnt vmcnt(4)
v_mfma_f32_16x16x16_bf16 v[112:115], v[52:53], v[102:103], v[112:115]
v_mfma_f32_16x16x16_bf16 v[116:119], v[54:55], v[102:103], v[116:119]
s_waitcnt vmcnt(3)
v_mfma_f32_16x16x16_bf16 v[112:115], v[56:57], v[104:105], v[112:115]
v_mfma_f32_16x16x16_bf16 v[116:119], v[58:59], v[104:105], v[116:119]
s_waitcnt vmcnt(2)
v_mfma_f32_16x16x16_bf16 v[112:115], v[60:61], v[106:107], v[112:115]
v_mfma_f32_16x16x16_bf16 v[116:119], v[62:63], v[106:107], v[116:119]
s_waitcnt vmcnt(1)
v_mfma_f32_16x16x16_bf16 v[112:115], v[64:65], v[108:109], v[112:115]
v_mfma_f32_16x16x16_bf16 v[116:119], v[66:67], v[108:109], v[116:119]
s_waitcnt vmcnt(0)
v_mfma_f32_16x16x16_bf16 v[112:115], v[68:69], v[110:111], v[112:115]
v_mfma_f32_16x16x16_bf16 v[116:119], v[70:71], v[110:111], v[116:119]
s_nop 7
s_lshl_b32 s57, s56, 11
v_lshlrev_b32 v6, 4, v0
v_add_u32 v6, s57, v6
ds_write_b128 v6, v[112:115] offset:24576
ds_write_b128 v6, v[116:119] offset:25600
s_waitcnt lgkmcnt(0)
v_mov_b32 v7, 41356
v_mov_b32 v8, 1
s_mov_b64 exec, 1
ds_add_u32 v7, v8
s_mov_b64 exec, -1
s_cmp_ge_u32 s56, 2
s_cbranch_scc1 L_end
s_branch L_kv_comb
L_kvp_f4:
v_add_u32 v1, s57, v6
v_add_u32 v2, s57, v8
buffer_load_dwordx4 v[40:43], v1, s[4:7], 0 offen offset:0 nt
buffer_load_dwordx4 v[44:47], v1, s[4:7], 0 offen offset:1024 nt
s_barrier
v_mov_b32 v6, 41352
s_waitcnt vmcnt(2)
ds_read_b32 v7, v6
s_waitcnt lgkmcnt(0)
v_readfirstlane_b32 s57, v7
s_cmp_ge_u32 s57, 4
s_cbranch_scc1 L_kvf_78
buffer_load_dwordx4 v[48:51], v1, s[4:7], 0 offen offset:2048 nt
s_waitcnt vmcnt(2)
ds_read_b32 v7, v6
s_waitcnt lgkmcnt(0)
v_readfirstlane_b32 s57, v7
s_cmp_ge_u32 s57, 4
s_cbranch_scc1 L_kvf_79
buffer_load_dwordx4 v[52:55], v1, s[4:7], 0 offen offset:3072 nt
s_waitcnt vmcnt(2)
ds_read_b32 v7, v6
s_waitcnt lgkmcnt(0)
v_readfirstlane_b32 s57, v7
s_cmp_ge_u32 s57, 4
s_cbranch_scc1 L_kvf_80
buffer_load_dwordx4 v[56:59], v1, s[4:7], s80 offen offset:0 nt
s_waitcnt vmcnt(2)
ds_read_b32 v7, v6
s_waitcnt lgkmcnt(0)
v_readfirstlane_b32 s57, v7
s_cmp_ge_u32 s57, 4
s_cbranch_scc1 L_kvf_81
buffer_load_dwordx4 v[60:63], v1, s[4:7], s80 offen offset:1024 nt
s_waitcnt vmcnt(2)
ds_read_b32 v7, v6
s_waitcnt lgkmcnt(0)
v_readfirstlane_b32 s57, v7
s_cmp_ge_u32 s57, 4
s_cbranch_scc1 L_kvf_82
buffer_load_dwordx4 v[64:67], v1, s[4:7], s80 offen offset:2048 nt
s_waitcnt vmcnt(2)
ds_read_b32 v7, v6
s_waitcnt lgkmcnt(0)
v_readfirstlane_b32 s57, v7
s_cmp_ge_u32 s57, 4
s_cbranch_scc1 L_kvf_83
buffer_load_dwordx4 v[68:71], v1, s[4:7], s80 offen offset:3072 nt
s_waitcnt vmcnt(2)
ds_read_b32 v7, v6
s_waitcnt lgkmcnt(0)
v_readfirstlane_b32 s57, v7
s_cmp_ge_u32 s57, 4
s_cbranch_scc1 L_kvf_84
buffer_load_dwordx4 v[72:75], v1, s[4:7], s81 offen offset:0 nt
s_waitcnt vmcnt(2)
ds_read_b32 v7, v6
s_waitcnt lgkmcnt(0)
v_readfirstlane_b32 s57, v7
s_cmp_ge_u32 s57, 4
s_cbranch_scc1 L_kvf_85
buffer_load_dwordx4 v[76:79], v1, s[4:7], s81 offen offset:1024 nt
s_waitcnt vmcnt(2)
ds_read_b32 v7, v6
s_waitcnt lgkmcnt(0)
v_readfirstlane_b32 s57, v7
s_cmp_ge_u32 s57, 4
s_cbranch_scc1 L_kvf_86
buffer_load_dwordx4 v[80:83], v1, s[4:7], s81 offen offset:2048 nt
s_waitcnt vmcnt(2)
ds_read_b32 v7, v6
s_waitcnt lgkmcnt(0)
v_readfirstlane_b32 s57, v7
s_cmp_ge_u32 s57, 4
s_cbranch_scc1 L_kvf_87
buffer_load_dwordx4 v[84:87], v1, s[4:7], s81 offen offset:3072 nt
s_waitcnt vmcnt(2)
ds_read_b32 v7, v6
s_waitcnt lgkmcnt(0)
v_readfirstlane_b32 s57, v7
s_cmp_ge_u32 s57, 4
s_cbranch_scc1 L_kvf_88
buffer_load_dwordx4 v[88:91], v1, s[4:7], s82 offen offset:0 nt
s_waitcnt vmcnt(2)
ds_read_b32 v7, v6
s_waitcnt lgkmcnt(0)
v_readfirstlane_b32 s57, v7
s_cmp_ge_u32 s57, 4
s_cbranch_scc1 L_kvf_89
buffer_load_dwordx4 v[92:95], v1, s[4:7], s82 offen offset:1024 nt
s_waitcnt vmcnt(2)
ds_read_b32 v7, v6
s_waitcnt lgkmcnt(0)
v_readfirstlane_b32 s57, v7
s_cmp_ge_u32 s57, 4
s_cbranch_scc1 L_kvf_90
buffer_load_dwordx4 v[96:99], v1, s[4:7], s82 offen offset:2048 nt
s_waitcnt vmcnt(2)
ds_read_b32 v7, v6
s_waitcnt lgkmcnt(0)
v_readfirstlane_b32 s57, v7
s_cmp_ge_u32 s57, 4
s_cbranch_scc1 L_kvf_91
buffer_load_dwordx4 v[100:103], v1, s[4:7], s82 offen offset:3072 nt
s_waitcnt vmcnt(2)
ds_read_b32 v7, v6
s_waitcnt lgkmcnt(0)
v_readfirstlane_b32 s57, v7
s_cmp_ge_u32 s57, 4
s_cbranch_scc1 L_kvf_92
buffer_load_dwordx4 v[104:107], v2, s[8:11], 0 offen offset:0 nt
s_waitcnt vmcnt(2)
ds_read_b32 v7, v6
s_waitcnt lgkmcnt(0)
v_readfirstlane_b32 s57, v7
s_cmp_ge_u32 s57, 4
s_cbranch_scc1 L_kvf_93
buffer_load_dwordx4 v[108:111], v2, s[8:11], 0 offen offset:1024 nt
s_waitcnt vmcnt(2)
ds_read_b32 v7, v6
s_waitcnt lgkmcnt(0)
v_readfirstlane_b32 s57, v7
s_cmp_ge_u32 s57, 4
s_cbranch_scc1 L_kvf_94
buffer_load_dwordx4 v[112:115], v2, s[8:11], 0 offen offset:2048 nt
s_waitcnt vmcnt(2)
ds_read_b32 v7, v6
s_waitcnt lgkmcnt(0)
v_readfirstlane_b32 s57, v7
s_cmp_ge_u32 s57, 4
s_cbranch_scc1 L_kvf_95
buffer_load_dwordx4 v[116:119], v2, s[8:11], 0 offen offset:3072 nt
s_waitcnt vmcnt(2)
ds_read_b32 v7, v6
s_waitcnt lgkmcnt(0)
v_readfirstlane_b32 s57, v7
s_cmp_ge_u32 s57, 4
s_cbranch_scc1 L_kvf_96
buffer_load_dwordx4 v[120:123], v2, s[8:11], s80 offen offset:0 nt
s_waitcnt vmcnt(2)
ds_read_b32 v7, v6
s_waitcnt lgkmcnt(0)
v_readfirstlane_b32 s57, v7
s_cmp_ge_u32 s57, 4
s_cbranch_scc1 L_kvf_97
buffer_load_dwordx4 v[124:127], v2, s[8:11], s80 offen offset:1024 nt
s_waitcnt vmcnt(2)
ds_read_b32 v7, v6
s_waitcnt lgkmcnt(0)
v_readfirstlane_b32 s57, v7
s_cmp_ge_u32 s57, 4
s_cbranch_scc1 L_kvf_98
buffer_load_dwordx4 v[128:131], v2, s[8:11], s80 offen offset:2048 nt
s_waitcnt vmcnt(2)
ds_read_b32 v7, v6
s_waitcnt lgkmcnt(0)
v_readfirstlane_b32 s57, v7
s_cmp_ge_u32 s57, 4
s_cbranch_scc1 L_kvf_99
buffer_load_dwordx4 v[132:135], v2, s[8:11], s80 offen offset:3072 nt
s_waitcnt vmcnt(2)
ds_read_b32 v7, v6
s_waitcnt lgkmcnt(0)
v_readfirstlane_b32 s57, v7
s_cmp_ge_u32 s57, 4
s_cbranch_scc1 L_kvf_100
buffer_load_dwordx4 v[136:139], v2, s[8:11], s81 offen offset:0 nt
s_waitcnt vmcnt(2)
ds_read_b32 v7, v6
s_waitcnt lgkmcnt(0)
v_readfirstlane_b32 s57, v7
s_cmp_ge_u32 s57, 4
s_cbranch_scc1 L_kvf_101
buffer_load_dwordx4 v[140:143], v2, s[8:11], s81 offen offset:1024 nt
s_waitcnt vmcnt(2)
ds_read_b32 v7, v6
s_waitcnt lgkmcnt(0)
v_readfirstlane_b32 s57, v7
s_cmp_ge_u32 s57, 4
s_cbranch_scc1 L_kvf_102
buffer_load_dwordx4 v[144:147], v2, s[8:11], s81 offen offset:2048 nt
s_waitcnt vmcnt(2)
ds_read_b32 v7, v6
s_waitcnt lgkmcnt(0)
v_readfirstlane_b32 s57, v7
s_cmp_ge_u32 s57, 4
s_cbranch_scc1 L_kvf_103
buffer_load_dwordx4 v[148:151], v2, s[8:11], s81 offen offset:3072 nt
s_waitcnt vmcnt(2)
ds_read_b32 v7, v6
s_waitcnt lgkmcnt(0)
v_readfirstlane_b32 s57, v7
s_cmp_ge_u32 s57, 4
s_cbranch_scc1 L_kvf_104
buffer_load_dwordx4 v[152:155], v2, s[8:11], s82 offen offset:0 nt
s_waitcnt vmcnt(2)
ds_read_b32 v7, v6
s_waitcnt lgkmcnt(0)
v_readfirstlane_b32 s57, v7
s_cmp_ge_u32 s57, 4
s_cbranch_scc1 L_kvf_105
buffer_load_dwordx4 v[156:159], v2, s[8:11], s82 offen offset:1024 nt
s_waitcnt vmcnt(2)
ds_read_b32 v7, v6
s_waitcnt lgkmcnt(0)
v_readfirstlane_b32 s57, v7
s_cmp_ge_u32 s57, 4
s_cbranch_scc1 L_kvf_106
buffer_load_dwordx4 v[160:163], v2, s[8:11], s82 offen offset:2048 nt
s_waitcnt vmcnt(2)
ds_read_b32 v7, v6
s_waitcnt lgkmcnt(0)
v_readfirstlane_b32 s57, v7
s_cmp_ge_u32 s57, 4
s_cbranch_scc1 L_kvf_107
buffer_load_dwordx4 v[164:167], v2, s[8:11], s82 offen offset:3072 nt
s_branch L_kvall_75
L_kvf_78:
buffer_load_dwordx4 v[48:51], v1, s[4:7], 0 offen offset:2048 nt
L_kvf_79:
buffer_load_dwordx4 v[52:55], v1, s[4:7], 0 offen offset:3072 nt
L_kvf_80:
buffer_load_dwordx4 v[56:59], v1, s[4:7], s80 offen offset:0 nt
L_kvf_81:
buffer_load_dwordx4 v[60:63], v1, s[4:7], s80 offen offset:1024 nt
L_kvf_82:
buffer_load_dwordx4 v[64:67], v1, s[4:7], s80 offen offset:2048 nt
L_kvf_83:
buffer_load_dwordx4 v[68:71], v1, s[4:7], s80 offen offset:3072 nt
L_kvf_84:
buffer_load_dwordx4 v[72:75], v1, s[4:7], s81 offen offset:0 nt
L_kvf_85:
buffer_load_dwordx4 v[76:79], v1, s[4:7], s81 offen offset:1024 nt
L_kvf_86:
buffer_load_dwordx4 v[80:83], v1, s[4:7], s81 offen offset:2048 nt
L_kvf_87:
buffer_load_dwordx4 v[84:87], v1, s[4:7], s81 offen offset:3072 nt
L_kvf_88:
buffer_load_dwordx4 v[88:91], v1, s[4:7], s82 offen offset:0 nt
L_kvf_89:
buffer_load_dwordx4 v[92:95], v1, s[4:7], s82 offen offset:1024 nt
L_kvf_90:
buffer_load_dwordx4 v[96:99], v1, s[4:7], s82 offen offset:2048 nt
L_kvf_91:
buffer_load_dwordx4 v[100:103], v1, s[4:7], s82 offen offset:3072 nt
L_kvf_92:
buffer_load_dwordx4 v[104:107], v2, s[8:11], 0 offen offset:0 nt
L_kvf_93:
buffer_load_dwordx4 v[108:111], v2, s[8:11], 0 offen offset:1024 nt
L_kvf_94:
buffer_load_dwordx4 v[112:115], v2, s[8:11], 0 offen offset:2048 nt
L_kvf_95:
buffer_load_dwordx4 v[116:119], v2, s[8:11], 0 offen offset:3072 nt
L_kvf_96:
buffer_load_dwordx4 v[120:123], v2, s[8:11], s80 offen offset:0 nt
L_kvf_97:
buffer_load_dwordx4 v[124:127], v2, s[8:11], s80 offen offset:1024 nt
L_kvf_98:
buffer_load_dwordx4 v[128:131], v2, s[8:11], s80 offen offset:2048 nt
L_kvf_99:
buffer_load_dwordx4 v[132:135], v2, s[8:11], s80 offen offset:3072 nt
L_kvf_100:
buffer_load_dwordx4 v[136:139], v2, s[8:11], s81 offen offset:0 nt
L_kvf_101:
buffer_load_dwordx4 v[140:143], v2, s[8:11], s81 offen offset:1024 nt
L_kvf_102:
buffer_load_dwordx4 v[144:147], v2, s[8:11], s81 offen offset:2048 nt
L_kvf_103:
buffer_load_dwordx4 v[148:151], v2, s[8:11], s81 offen offset:3072 nt
L_kvf_104:
buffer_load_dwordx4 v[152:155], v2, s[8:11], s82 offen offset:0 nt
L_kvf_105:
buffer_load_dwordx4 v[156:159], v2, s[8:11], s82 offen offset:1024 nt
L_kvf_106:
buffer_load_dwordx4 v[160:163], v2, s[8:11], s82 offen offset:2048 nt
L_kvf_107:
buffer_load_dwordx4 v[164:167], v2, s[8:11], s82 offen offset:3072 nt
L_kvall_75:
v_mov_b32 v6, 0xffff
v_mov_b32 v4, s91
v_cndmask_b32 v4, v6, v4, s[60:61]
v_mov_b32 v6, 0
v_cndmask_b32 v5, v6, v4, s[62:63]
v_cndmask_b32 v4, v4, v6, s[62:63]
s_waitcnt lgkmcnt(0)
s_add_u32 s59, s59, 1
s_and_b32 s53, s59, 0xffff
s_and_b32 s94, s59, 15
v_mov_b32 v3, s53
v_mov_b32 v6, 41352
s_mov_b32 s55, 0
L_lw_108:
ds_read_b32 v7, v6
s_waitcnt lgkmcnt(0)
v_readfirstlane_b32 s57, v7
s_add_u32 s55, s55, 1
s_cmp_ge_u32 s57, 4
s_cbranch_scc1 L_lwd_109
s_sleep 1
s_cmp_lt_u32 s55, 400000
s_cbranch_scc1 L_lw_108
L_lwd_109:
v_bfe_u32 v6, v0, 2, 2
v_lshlrev_b32 v6, 8, v6
v_lshrrev_b32 v7, 4, v0
v_lshl_add_u32 v6, v7, 6, v6
v_and_b32 v7, 3, v0
v_lshl_add_u32 v6, v7, 4, v6
ds_read_b128 v[12:15], v6 offset:20480
s_waitcnt lgkmcnt(0)
s_waitcnt vmcnt(28)
v_mfma_f32_16x16x32_bf16 v[16:19], v[40:43], v[12:15], 0
v_mfma_f32_16x16x32_bf16 v[20:23], v[44:47], v[12:15], 0
v_mfma_f32_16x16x32_bf16 v[24:27], v[48:51], v[12:15], 0
v_mfma_f32_16x16x32_bf16 v[28:31], v[52:55], v[12:15], 0
s_nop 7
v_cndmask_b32 v16, v16, v17, s[60:61]
v_cndmask_b32 v18, v18, v19, s[60:61]
v_cndmask_b32 v16, v16, v18, s[62:63]
v_cndmask_b32 v20, v20, v21, s[60:61]
v_cndmask_b32 v22, v22, v23, s[60:61]
v_cndmask_b32 v20, v20, v22, s[62:63]
v_cndmask_b32 v24, v24, v25, s[60:61]
v_cndmask_b32 v26, v26, v27, s[60:61]
v_cndmask_b32 v24, v24, v26, s[62:63]
v_cndmask_b32 v28, v28, v29, s[60:61]
v_cndmask_b32 v30, v30, v31, s[60:61]
v_cndmask_b32 v28, v28, v30, s[62:63]
v_cndmask_b32 v17, v16, v20, s[60:61]
v_cndmask_b32 v18, v20, v16, s[60:61]
v_cndmask_b32 v25, v24, v28, s[60:61]
v_cndmask_b32 v26, v28, v24, s[60:61]
s_nop 0
v_add_f32_dpp v16, v18, v17 quad_perm:[1,0,3,2] row_mask:0xf bank_mask:0xf
v_add_f32_dpp v24, v26, v25 quad_perm:[1,0,3,2] row_mask:0xf bank_mask:0xf
v_cndmask_b32 v17, v16, v24, s[62:63]
v_cndmask_b32 v18, v24, v16, s[62:63]
s_nop 1
v_add_f32_dpp v32, v18, v17 quad_perm:[2,3,0,1] row_mask:0xf bank_mask:0xf
s_waitcnt vmcnt(24)
v_mfma_f32_16x16x32_bf16 v[16:19], v[56:59], v[12:15], 0
v_mfma_f32_16x16x32_bf16 v[20:23], v[60:63], v[12:15], 0
v_mfma_f32_16x16x32_bf16 v[24:27], v[64:67], v[12:15], 0
v_mfma_f32_16x16x32_bf16 v[28:31], v[68:71], v[12:15], 0
s_nop 7
v_cndmask_b32 v16, v16, v17, s[60:61]
v_cndmask_b32 v18, v18, v19, s[60:61]
v_cndmask_b32 v16, v16, v18, s[62:63]
v_cndmask_b32 v20, v20, v21, s[60:61]
v_cndmask_b32 v22, v22, v23, s[60:61]
v_cndmask_b32 v20, v20, v22, s[62:63]
v_cndmask_b32 v24, v24, v25, s[60:61]
v_cndmask_b32 v26, v26, v27, s[60:61]
v_cndmask_b32 v24, v24, v26, s[62:63]
v_cndmask_b32 v28, v28, v29, s[60:61]
v_cndmask_b32 v30, v30, v31, s[60:61]
v_cndmask_b32 v28, v28, v30, s[62:63]
v_cndmask_b32 v17, v16, v20, s[60:61]
v_cndmask_b32 v18, v20, v16, s[60:61]
v_cndmask_b32 v25, v24, v28, s[60:61]
v_cndmask_b32 v26, v28, v24, s[60:61]
s_nop 0
v_add_f32_dpp v16, v18, v17 quad_perm:[1,0,3,2] row_mask:0xf bank_mask:0xf
v_add_f32_dpp v24, v26, v25 quad_perm:[1,0,3,2] row_mask:0xf bank_mask:0xf
v_cndmask_b32 v17, v16, v24, s[62:63]
v_cndmask_b32 v18, v24, v16, s[62:63]
s_nop 1
v_add_f32_dpp v33, v18, v17 quad_perm:[2,3,0,1] row_mask:0xf bank_mask:0xf
s_waitcnt vmcnt(20)
v_mfma_f32_16x16x32_bf16 v[16:19], v[72:75], v[12:15], 0
v_mfma_f32_16x16x32_bf16 v[20:23], v[76:79], v[12:15], 0
v_mfma_f32_16x16x32_bf16 v[24:27], v[80:83], v[12:15], 0
v_mfma_f32_16x16x32_bf16 v[28:31], v[84:87], v[12:15], 0
s_nop 7
v_cndmask_b32 v16, v16, v17, s[60:61]
v_cndmask_b32 v18, v18, v19, s[60:61]
v_cndmask_b32 v16, v16, v18, s[62:63]
v_cndmask_b32 v20, v20, v21, s[60:61]
v_cndmask_b32 v22, v22, v23, s[60:61]
v_cndmask_b32 v20, v20, v22, s[62:63]
v_cndmask_b32 v24, v24, v25, s[60:61]
v_cndmask_b32 v26, v26, v27, s[60:61]
v_cndmask_b32 v24, v24, v26, s[62:63]
v_cndmask_b32 v28, v28, v29, s[60:61]
v_cndmask_b32 v30, v30, v31, s[60:61]
v_cndmask_b32 v28, v28, v30, s[62:63]
v_cndmask_b32 v17, v16, v20, s[60:61]
v_cndmask_b32 v18, v20, v16, s[60:61]
v_cndmask_b32 v25, v24, v28, s[60:61]
v_cndmask_b32 v26, v28, v24, s[60:61]
s_nop 0
v_add_f32_dpp v16, v18, v17 quad_perm:[1,0,3,2] row_mask:0xf bank_mask:0xf
v_add_f32_dpp v24, v26, v25 quad_perm:[1,0,3,2] row_mask:0xf bank_mask:0xf
v_cndmask_b32 v17, v16, v24, s[62:63]
v_cndmask_b32 v18, v24, v16, s[62:63]
s_nop 1
v_add_f32_dpp v34, v18, v17 quad_perm:[2,3,0,1] row_mask:0xf bank_mask:0xf
s_waitcnt vmcnt(16)
v_mfma_f32_16x16x32_bf16 v[16:19], v[88:91], v[12:15], 0
v_mfma_f32_16x16x32_bf16 v[20:23], v[92:95], v[12:15], 0
v_mfma_f32_16x16x32_bf16 v[24:27], v[96:99], v[12:15], 0
v_mfma_f32_16x16x32_bf16 v[28:31], v[100:103], v[12:15], 0
s_nop 7
v_cndmask_b32 v16, v16, v17, s[60:61]
v_cndmask_b32 v18, v18, v19, s[60:61]
v_cndmask_b32 v16, v16, v18, s[62:63]
v_cndmask_b32 v20, v20, v21, s[60:61]
v_cndmask_b32 v22, v22, v23, s[60:61]
v_cndmask_b32 v20, v20, v22, s[62:63]
v_cndmask_b32 v24, v24, v25, s[60:61]
v_cndmask_b32 v26, v26, v27, s[60:61]
v_cndmask_b32 v24, v24, v26, s[62:63]
v_cndmask_b32 v28, v28, v29, s[60:61]
v_cndmask_b32 v30, v30, v31, s[60:61]
v_cndmask_b32 v28, v28, v30, s[62:63]
v_cndmask_b32 v17, v16, v20, s[60:61]
v_cndmask_b32 v18, v20, v16, s[60:61]
v_cndmask_b32 v25, v24, v28, s[60:61]
v_cndmask_b32 v26, v28, v24, s[60:61]
s_nop 0
v_add_f32_dpp v16, v18, v17 quad_perm:[1,0,3,2] row_mask:0xf bank_mask:0xf
v_add_f32_dpp v24, v26, v25 quad_perm:[1,0,3,2] row_mask:0xf bank_mask:0xf
v_cndmask_b32 v17, v16, v24, s[62:63]
v_cndmask_b32 v18, v24, v16, s[62:63]
s_nop 1
v_add_f32_dpp v35, v18, v17 quad_perm:[2,3,0,1] row_mask:0xf bank_mask:0xf
v_cvt_pk_bf16_f32 v6, v32, v33
v_lshlrev_b32 v32, 16, v6
v_and_b32 v33, s91, v6
v_cvt_pk_bf16_f32 v7, v34, v35
v_lshlrev_b32 v34, 16, v7
v_and_b32 v35, s91, v7
v_mul_f32 v32, 0x3db504f3, v32
v_mul_f32 v33, 0x3db504f3, v33
v_mul_f32 v34, 0x3db504f3, v34
v_mul_f32 v35, 0x3db504f3, v35
v_cvt_pk_bf16_f32 v6, v32, v33
v_lshlrev_b32 v32, 16, v6
v_and_b32 v33, s91, v6
v_cvt_pk_bf16_f32 v7, v34, v35
v_lshlrev_b32 v34, 16, v7
v_and_b32 v35, s91, v7
v_max3_f32 v38, v32, v33, v34
v_max_f32 v38, v38, v35
s_nop 1
v_max_f32_dpp v38, v38, v38 quad_perm:[1,0,3,2] row_mask:0xf bank_mask:0xf
s_nop 1
v_max_f32_dpp v38, v38, v38 quad_perm:[2,3,0,1] row_mask:0xf bank_mask:0xf
v_mov_b32 v6, v38
s_nop 1
v_permlane16_swap_b32 v38, v6
v_max_f32 v38, v38, v6
v_mov_b32 v6, v38
s_nop 1
v_permlane32_swap_b32 v38, v6
v_max_f32 v38, v38, v6
v_sub_f32 v32, v32, v38
v_sub_f32 v33, v33, v38
v_sub_f32 v34, v34, v38
v_sub_f32 v35, v35, v38
v_mul_f32 v32, 0x3fb8aa3b, v32
v_mul_f32 v33, 0x3fb8aa3b, v33
v_mul_f32 v34, 0x3fb8aa3b, v34
v_mul_f32 v35, 0x3fb8aa3b, v35
v_exp_f32 v32, v32
v_exp_f32 v33, v33
v_exp_f32 v34, v34
v_exp_f32 v35, v35
s_nop 0
v_add_f32 v39, v32, v33
v_add_f32 v39, v39, v34
v_add_f32 v39, v39, v35
v_cvt_pk_bf16_f32 v32, v32, v32
v_cvt_pk_bf16_f32 v33, v33, v33
v_cvt_pk_bf16_f32 v34, v34, v34
v_cvt_pk_bf16_f32 v35, v35, v35
s_nop 0
v_and_b32_dpp v40, v32, v4 quad_perm:[0,0,0,0] row_mask:0xf bank_mask:0xf
v_and_b32_dpp v41, v32, v5 quad_perm:[0,0,0,0] row_mask:0xf bank_mask:0xf
v_and_b32_dpp v42, v32, v4 quad_perm:[1,1,1,1] row_mask:0xf bank_mask:0xf
v_and_b32_dpp v43, v32, v5 quad_perm:[1,1,1,1] row_mask:0xf bank_mask:0xf
v_and_b32_dpp v44, v32, v4 quad_perm:[2,2,2,2] row_mask:0xf bank_mask:0xf
v_and_b32_dpp v45, v32, v5 quad_perm:[2,2,2,2] row_mask:0xf bank_mask:0xf
v_and_b32_dpp v46, v32, v4 quad_perm:[3,3,3,3] row_mask:0xf bank_mask:0xf
v_and_b32_dpp v47, v32, v5 quad_perm:[3,3,3,3] row_mask:0xf bank_mask:0xf
v_and_b32_dpp v48, v33, v4 quad_perm:[0,0,0,0] row_mask:0xf bank_mask:0xf
v_and_b32_dpp v49, v33, v5 quad_perm:[0,0,0,0] row_mask:0xf bank_mask:0xf
v_and_b32_dpp v50, v33, v4 quad_perm:[1,1,1,1] row_mask:0xf bank_mask:0xf
v_and_b32_dpp v51, v33, v5 quad_perm:[1,1,1,1] row_mask:0xf bank_mask:0xf
v_and_b32_dpp v52, v33, v4 quad_perm:[2,2,2,2] row_mask:0xf bank_mask:0xf
v_and_b32_dpp v53, v33, v5 quad_perm:[2,2,2,2] row_mask:0xf bank_mask:0xf
v_and_b32_dpp v54, v33, v4 quad_perm:[3,3,3,3] row_mask:0xf bank_mask:0xf
v_and_b32_dpp v55, v33, v5 quad_perm:[3,3,3,3] row_mask:0xf bank_mask:0xf
v_and_b32_dpp v56, v34, v4 quad_perm:[0,0,0,0] row_mask:0xf bank_mask:0xf
v_and_b32_dpp v57, v34, v5 quad_perm:[0,0,0,0] row_mask:0xf bank_mask:0xf
v_and_b32_dpp v58, v34, v4 quad_perm:[1,1,1,1] row_mask:0xf bank_mask:0xf
v_and_b32_dpp v59, v34, v5 quad_perm:[1,1,1,1] row_mask:0xf bank_mask:0xf
v_and_b32_dpp v60, v34, v4 quad_perm:[2,2,2,2] row_mask:0xf bank_mask:0xf
v_and_b32_dpp v61, v34, v5 quad_perm:[2,2,2,2] row_mask:0xf bank_mask:0xf
v_and_b32_dpp v62, v34, v4 quad_perm:[3,3,3,3] row_mask:0xf bank_mask:0xf
v_and_b32_dpp v63, v34, v5 quad_perm:[3,3,3,3] row_mask:0xf bank_mask:0xf
v_and_b32_dpp v64, v35, v4 quad_perm:[0,0,0,0] row_mask:0xf bank_mask:0xf
v_and_b32_dpp v65, v35, v5 quad_perm:[0,0,0,0] row_mask:0xf bank_mask:0xf
v_and_b32_dpp v66, v35, v4 quad_perm:[1,1,1,1] row_mask:0xf bank_mask:0xf
v_and_b32_dpp v67, v35, v5 quad_perm:[1,1,1,1] row_mask:0xf bank_mask:0xf
v_and_b32_dpp v68, v35, v4 quad_perm:[2,2,2,2] row_mask:0xf bank_mask:0xf
v_and_b32_dpp v69, v35, v5 quad_perm:[2,2,2,2] row_mask:0xf bank_mask:0xf
v_and_b32_dpp v70, v35, v4 quad_perm:[3,3,3,3] row_mask:0xf bank_mask:0xf
v_and_b32_dpp v71, v35, v5 quad_perm:[3,3,3,3] row_mask:0xf bank_mask:0xf
s_nop 1
v_add_f32_dpp v39, v39, v39 quad_perm:[1,0,3,2] row_mask:0xf bank_mask:0xf
s_nop 1
v_add_f32_dpp v39, v39, v39 quad_perm:[2,3,0,1] row_mask:0xf bank_mask:0xf
v_mov_b32 v6, v39
s_nop 1
v_permlane16_swap_b32 v39, v6
v_add_f32 v39, v39, v6
v_mov_b32 v6, v39
s_nop 1
v_permlane32_swap_b32 v39, v6
v_add_f32 v39, v39, v6
v_bfe_u32 v6, v0, 2, 2
v_lshlrev_b32 v6, 6, v6
s_lshl_b32 s57, s56, 3
v_add_u32 v6, s57, v6
s_mov_b64 exec, 0x1111
ds_write_b32 v6, v38 offset:40960
ds_write_b32 v6, v39 offset:40964
s_mov_b64 exec, -1
s_waitcnt vmcnt(15)
v_mfma_f32_16x16x16_bf16 v[72:75], v[104:105], v[40:41], 0
v_mfma_f32_16x16x16_bf16 v[76:79], v[106:107], v[40:41], 0
s_waitcnt vmcnt(14)
v_mfma_f32_16x16x16_bf16 v[80:83], v[108:109], v[42:43], 0
v_mfma_f32_16x16x16_bf16 v[84:87], v[110:111], v[42:43], 0
s_waitcnt vmcnt(13)
v_mfma_f32_16x16x16_bf16 v[72:75], v[112:113], v[44:45], v[72:75]
v_mfma_f32_16x16x16_bf16 v[76:79], v[114:115], v[44:45], v[76:79]
s_waitcnt vmcnt(12)
v_mfma_f32_16x16x16_bf16 v[80:83], v[116:117], v[46:47], v[80:83]
v_mfma_f32_16x16x16_bf16 v[84:87], v[118:119], v[46:47], v[84:87]
s_waitcnt vmcnt(11)
v_mfma_f32_16x16x16_bf16 v[72:75], v[120:121], v[48:49], v[72:75]
v_mfma_f32_16x16x16_bf16 v[76:79], v[122:123], v[48:49], v[76:79]
s_waitcnt vmcnt(10)
v_mfma_f32_16x16x16_bf16 v[80:83], v[124:125], v[50:51], v[80:83]
v_mfma_f32_16x16x16_bf16 v[84:87], v[126:127], v[50:51], v[84:87]
s_waitcnt vmcnt(9)
v_mfma_f32_16x16x16_bf16 v[72:75], v[128:129], v[52:53], v[72:75]
v_mfma_f32_16x16x16_bf16 v[76:79], v[130:131], v[52:53], v[76:79]
s_waitcnt vmcnt(8)
v_mfma_f32_16x16x16_bf16 v[80:83], v[132:133], v[54:55], v[80:83]
v_mfma_f32_16x16x16_bf16 v[84:87], v[134:135], v[54:55], v[84:87]
s_waitcnt vmcnt(7)
v_mfma_f32_16x16x16_bf16 v[72:75], v[136:137], v[56:57], v[72:75]
v_mfma_f32_16x16x16_bf16 v[76:79], v[138:139], v[56:57], v[76:79]
s_waitcnt vmcnt(6)
v_mfma_f32_16x16x16_bf16 v[80:83], v[140:141], v[58:59], v[80:83]
v_mfma_f32_16x16x16_bf16 v[84:87], v[142:143], v[58:59], v[84:87]
s_waitcnt vmcnt(5)
v_mfma_f32_16x16x16_bf16 v[72:75], v[144:145], v[60:61], v[72:75]
v_mfma_f32_16x16x16_bf16 v[76:79], v[146:147], v[60:61], v[76:79]
s_waitcnt vmcnt(4)
v_mfma_f32_16x16x16_bf16 v[80:83], v[148:149], v[62:63], v[80:83]
v_mfma_f32_16x16x16_bf16 v[84:87], v[150:151], v[62:63], v[84:87]
s_waitcnt vmcnt(3)
v_mfma_f32_16x16x16_bf16 v[72:75], v[152:153], v[64:65], v[72:75]
v_mfma_f32_16x16x16_bf16 v[76:79], v[154:155], v[64:65], v[76:79]
s_waitcnt vmcnt(2)
v_mfma_f32_16x16x16_bf16 v[80:83], v[156:157], v[66:67], v[80:83]
v_mfma_f32_16x16x16_bf16 v[84:87], v[158:159], v[66:67], v[84:87]
s_waitcnt vmcnt(1)
v_mfma_f32_16x16x16_bf16 v[72:75], v[160:161], v[68:69], v[72:75]
v_mfma_f32_16x16x16_bf16 v[76:79], v[162:163], v[68:69], v[76:79]
s_waitcnt vmcnt(0)
v_mfma_f32_16x16x16_bf16 v[80:83], v[164:165], v[70:71], v[80:83]
v_mfma_f32_16x16x16_bf16 v[84:87], v[166:167], v[70:71], v[84:87]
s_nop 7
v_add_f32 v72, v72, v80
v_add_f32 v73, v73, v81
v_add_f32 v74, v74, v82
v_add_f32 v75, v75, v83
v_add_f32 v76, v76, v84
v_add_f32 v77, v77, v85
v_add_f32 v78, v78, v86
v_add_f32 v79, v79, v87
s_lshl_b32 s57, s56, 11
v_lshlrev_b32 v6, 4, v0
v_add_u32 v6, s57, v6
ds_write_b128 v6, v[72:75] offset:24576
ds_write_b128 v6, v[76:79] offset:25600
s_waitcnt lgkmcnt(0)
v_mov_b32 v7, 41356
v_mov_b32 v8, 1
s_mov_b64 exec, 1
ds_add_u32 v7, v8
s_mov_b64 exec, -1
s_cmp_ge_u32 s56, 2
s_cbranch_scc1 L_end
s_branch L_kv_comb
L_kvp_n4:
v_add_u32 v1, s57, v6
v_add_u32 v2, s57, v8
buffer_load_dwordx4 v[40:43], v1, s[4:7], 0 offen offset:0 nt
buffer_load_dwordx4 v[44:47], v1, s[4:7], 0 offen offset:1024 nt
buffer_load_dwordx4 v[48:51], v1, s[4:7], 0 offen offset:2048 nt
buffer_load_dwordx4 v[52:55], v1, s[4:7], 0 offen offset:3072 nt
buffer_load_dwordx4 v[56:59], v1, s[4:7], s80 offen offset:0 nt
buffer_load_dwordx4 v[60:63], v1, s[4:7], s80 offen offset:1024 nt
buffer_load_dwordx4 v[64:67], v1, s[4:7], s80 offen offset:2048 nt
buffer_load_dwordx4 v[68:71], v1, s[4:7], s80 offen offset:3072 nt
buffer_load_dwordx4 v[72:75], v1, s[4:7], s81 offen offset:0 nt
buffer_load_dwordx4 v[76:79], v1, s[4:7], s81 offen offset:1024 nt
buffer_load_dwordx4 v[80:83], v1, s[4:7], s81 offen offset:2048 nt
buffer_load_dwordx4 v[84:87], v1, s[4:7], s81 offen offset:3072 nt
buffer_load_dwordx4 v[88:91], v1, s[4:7], s82 offen offset:0 nt
buffer_load_dwordx4 v[92:95], v1, s[4:7], s82 offen offset:1024 nt
buffer_load_dwordx4 v[96:99], v1, s[4:7], s82 offen offset:2048 nt
buffer_load_dwordx4 v[100:103], v1, s[4:7], s82 offen offset:3072 nt
buffer_load_dwordx4 v[104:107], v2, s[8:11], 0 offen offset:0 nt
buffer_load_dwordx4 v[108:111], v2, s[8:11], 0 offen offset:1024 nt
buffer_load_dwordx4 v[112:115], v2, s[8:11], 0 offen offset:2048 nt
buffer_load_dwordx4 v[116:119], v2, s[8:11], 0 offen offset:3072 nt
buffer_load_dwordx4 v[120:123], v2, s[8:11], s80 offen offset:0 nt
buffer_load_dwordx4 v[124:127], v2, s[8:11], s80 offen offset:1024 nt
buffer_load_dwordx4 v[128:131], v2, s[8:11], s80 offen offset:2048 nt
buffer_load_dwordx4 v[132:135], v2, s[8:11], s80 offen offset:3072 nt
buffer_load_dwordx4 v[136:139], v2, s[8:11], s81 offen offset:0 nt
buffer_load_dwordx4 v[140:143], v2, s[8:11], s81 offen offset:1024 nt
buffer_load_dwordx4 v[144:147], v2, s[8:11], s81 offen offset:2048 nt
buffer_load_dwordx4 v[148:151], v2, s[8:11], s81 offen offset:3072 nt
buffer_load_dwordx4 v[152:155], v2, s[8:11], s82 offen offset:0 nt
buffer_load_dwordx4 v[156:159], v2, s[8:11], s82 offen offset:1024 nt
buffer_load_dwordx4 v[160:163], v2, s[8:11], s82 offen offset:2048 nt
buffer_load_dwordx4 v[164:167], v2, s[8:11], s82 offen offset:3072 nt
s_barrier
L_kvall_110:
v_mov_b32 v6, 0xffff
v_mov_b32 v4, s91
v_cndmask_b32 v4, v6, v4, s[60:61]
v_mov_b32 v6, 0
v_cndmask_b32 v5, v6, v4, s[62:63]
v_cndmask_b32 v4, v4, v6, s[62:63]
s_waitcnt lgkmcnt(0)
s_add_u32 s59, s59, 1
s_and_b32 s53, s59, 0xffff
s_and_b32 s94, s59, 15
v_mov_b32 v3, s53
v_mov_b32 v6, 41352
s_mov_b32 s55, 0
L_lw_111:
ds_read_b32 v7, v6
s_waitcnt lgkmcnt(0)
v_readfirstlane_b32 s57, v7
s_add_u32 s55, s55, 1
s_cmp_ge_u32 s57, 4
s_cbranch_scc1 L_lwd_112
s_sleep 1
s_cmp_lt_u32 s55, 400000
s_cbranch_scc1 L_lw_111
L_lwd_112:
v_bfe_u32 v6, v0, 2, 2
v_lshlrev_b32 v6, 8, v6
v_lshrrev_b32 v7, 4, v0
v_lshl_add_u32 v6, v7, 6, v6
v_and_b32 v7, 3, v0
v_lshl_add_u32 v6, v7, 4, v6
ds_read_b128 v[12:15], v6 offset:20480
s_waitcnt lgkmcnt(0)
s_waitcnt vmcnt(28)
v_mfma_f32_16x16x32_bf16 v[16:19], v[40:43], v[12:15], 0
v_mfma_f32_16x16x32_bf16 v[20:23], v[44:47], v[12:15], 0
v_mfma_f32_16x16x32_bf16 v[24:27], v[48:51], v[12:15], 0
v_mfma_f32_16x16x32_bf16 v[28:31], v[52:55], v[12:15], 0
s_nop 7
v_cndmask_b32 v16, v16, v17, s[60:61]
v_cndmask_b32 v18, v18, v19, s[60:61]
v_cndmask_b32 v16, v16, v18, s[62:63]
v_cndmask_b32 v20, v20, v21, s[60:61]
v_cndmask_b32 v22, v22, v23, s[60:61]
v_cndmask_b32 v20, v20, v22, s[62:63]
v_cndmask_b32 v24, v24, v25, s[60:61]
v_cndmask_b32 v26, v26, v27, s[60:61]
v_cndmask_b32 v24, v24, v26, s[62:63]
v_cndmask_b32 v28, v28, v29, s[60:61]
v_cndmask_b32 v30, v30, v31, s[60:61]
v_cndmask_b32 v28, v28, v30, s[62:63]
v_cndmask_b32 v17, v16, v20, s[60:61]
v_cndmask_b32 v18, v20, v16, s[60:61]
v_cndmask_b32 v25, v24, v28, s[60:61]
v_cndmask_b32 v26, v28, v24, s[60:61]
s_nop 0
v_add_f32_dpp v16, v18, v17 quad_perm:[1,0,3,2] row_mask:0xf bank_mask:0xf
v_add_f32_dpp v24, v26, v25 quad_perm:[1,0,3,2] row_mask:0xf bank_mask:0xf
v_cndmask_b32 v17, v16, v24, s[62:63]
v_cndmask_b32 v18, v24, v16, s[62:63]
s_nop 1
v_add_f32_dpp v32, v18, v17 quad_perm:[2,3,0,1] row_mask:0xf bank_mask:0xf
s_waitcnt vmcnt(24)
v_mfma_f32_16x16x32_bf16 v[16:19], v[56:59], v[12:15], 0
v_mfma_f32_16x16x32_bf16 v[20:23], v[60:63], v[12:15], 0
v_mfma_f32_16x16x32_bf16 v[24:27], v[64:67], v[12:15], 0
v_mfma_f32_16x16x32_bf16 v[28:31], v[68:71], v[12:15], 0
s_nop 7
v_cndmask_b32 v16, v16, v17, s[60:61]
v_cndmask_b32 v18, v18, v19, s[60:61]
v_cndmask_b32 v16, v16, v18, s[62:63]
v_cndmask_b32 v20, v20, v21, s[60:61]
v_cndmask_b32 v22, v22, v23, s[60:61]
v_cndmask_b32 v20, v20, v22, s[62:63]
v_cndmask_b32 v24, v24, v25, s[60:61]
v_cndmask_b32 v26, v26, v27, s[60:61]
v_cndmask_b32 v24, v24, v26, s[62:63]
v_cndmask_b32 v28, v28, v29, s[60:61]
v_cndmask_b32 v30, v30, v31, s[60:61]
v_cndmask_b32 v28, v28, v30, s[62:63]
v_cndmask_b32 v17, v16, v20, s[60:61]
v_cndmask_b32 v18, v20, v16, s[60:61]
v_cndmask_b32 v25, v24, v28, s[60:61]
v_cndmask_b32 v26, v28, v24, s[60:61]
s_nop 0
v_add_f32_dpp v16, v18, v17 quad_perm:[1,0,3,2] row_mask:0xf bank_mask:0xf
v_add_f32_dpp v24, v26, v25 quad_perm:[1,0,3,2] row_mask:0xf bank_mask:0xf
v_cndmask_b32 v17, v16, v24, s[62:63]
v_cndmask_b32 v18, v24, v16, s[62:63]
s_nop 1
v_add_f32_dpp v33, v18, v17 quad_perm:[2,3,0,1] row_mask:0xf bank_mask:0xf
s_waitcnt vmcnt(20)
v_mfma_f32_16x16x32_bf16 v[16:19], v[72:75], v[12:15], 0
v_mfma_f32_16x16x32_bf16 v[20:23], v[76:79], v[12:15], 0
v_mfma_f32_16x16x32_bf16 v[24:27], v[80:83], v[12:15], 0
v_mfma_f32_16x16x32_bf16 v[28:31], v[84:87], v[12:15], 0
s_nop 7
v_cndmask_b32 v16, v16, v17, s[60:61]
v_cndmask_b32 v18, v18, v19, s[60:61]
v_cndmask_b32 v16, v16, v18, s[62:63]
v_cndmask_b32 v20, v20, v21, s[60:61]
v_cndmask_b32 v22, v22, v23, s[60:61]
v_cndmask_b32 v20, v20, v22, s[62:63]
v_cndmask_b32 v24, v24, v25, s[60:61]
v_cndmask_b32 v26, v26, v27, s[60:61]
v_cndmask_b32 v24, v24, v26, s[62:63]
v_cndmask_b32 v28, v28, v29, s[60:61]
v_cndmask_b32 v30, v30, v31, s[60:61]
v_cndmask_b32 v28, v28, v30, s[62:63]
v_cndmask_b32 v17, v16, v20, s[60:61]
v_cndmask_b32 v18, v20, v16, s[60:61]
v_cndmask_b32 v25, v24, v28, s[60:61]
v_cndmask_b32 v26, v28, v24, s[60:61]
s_nop 0
v_add_f32_dpp v16, v18, v17 quad_perm:[1,0,3,2] row_mask:0xf bank_mask:0xf
v_add_f32_dpp v24, v26, v25 quad_perm:[1,0,3,2] row_mask:0xf bank_mask:0xf
v_cndmask_b32 v17, v16, v24, s[62:63]
v_cndmask_b32 v18, v24, v16, s[62:63]
s_nop 1
v_add_f32_dpp v34, v18, v17 quad_perm:[2,3,0,1] row_mask:0xf bank_mask:0xf
s_waitcnt vmcnt(16)
v_mfma_f32_16x16x32_bf16 v[16:19], v[88:91], v[12:15], 0
v_mfma_f32_16x16x32_bf16 v[20:23], v[92:95], v[12:15], 0
v_mfma_f32_16x16x32_bf16 v[24:27], v[96:99], v[12:15], 0
v_mfma_f32_16x16x32_bf16 v[28:31], v[100:103], v[12:15], 0
s_nop 7
v_cndmask_b32 v16, v16, v17, s[60:61]
v_cndmask_b32 v18, v18, v19, s[60:61]
v_cndmask_b32 v16, v16, v18, s[62:63]
v_cndmask_b32 v20, v20, v21, s[60:61]
v_cndmask_b32 v22, v22, v23, s[60:61]
v_cndmask_b32 v20, v20, v22, s[62:63]
v_cndmask_b32 v24, v24, v25, s[60:61]
v_cndmask_b32 v26, v26, v27, s[60:61]
v_cndmask_b32 v24, v24, v26, s[62:63]
v_cndmask_b32 v28, v28, v29, s[60:61]
v_cndmask_b32 v30, v30, v31, s[60:61]
v_cndmask_b32 v28, v28, v30, s[62:63]
v_cndmask_b32 v17, v16, v20, s[60:61]
v_cndmask_b32 v18, v20, v16, s[60:61]
v_cndmask_b32 v25, v24, v28, s[60:61]
v_cndmask_b32 v26, v28, v24, s[60:61]
s_nop 0
v_add_f32_dpp v16, v18, v17 quad_perm:[1,0,3,2] row_mask:0xf bank_mask:0xf
v_add_f32_dpp v24, v26, v25 quad_perm:[1,0,3,2] row_mask:0xf bank_mask:0xf
v_cndmask_b32 v17, v16, v24, s[62:63]
v_cndmask_b32 v18, v24, v16, s[62:63]
s_nop 1
v_add_f32_dpp v35, v18, v17 quad_perm:[2,3,0,1] row_mask:0xf bank_mask:0xf
v_cvt_pk_bf16_f32 v6, v32, v33
v_lshlrev_b32 v32, 16, v6
v_and_b32 v33, s91, v6
v_cvt_pk_bf16_f32 v7, v34, v35
v_lshlrev_b32 v34, 16, v7
v_and_b32 v35, s91, v7
v_mul_f32 v32, 0x3db504f3, v32
v_mul_f32 v33, 0x3db504f3, v33
v_mul_f32 v34, 0x3db504f3, v34
v_mul_f32 v35, 0x3db504f3, v35
v_cvt_pk_bf16_f32 v6, v32, v33
v_lshlrev_b32 v32, 16, v6
v_and_b32 v33, s91, v6
v_cvt_pk_bf16_f32 v7, v34, v35
v_lshlrev_b32 v34, 16, v7
v_and_b32 v35, s91, v7
v_max3_f32 v38, v32, v33, v34
v_max_f32 v38, v38, v35
s_nop 1
v_max_f32_dpp v38, v38, v38 quad_perm:[1,0,3,2] row_mask:0xf bank_mask:0xf
s_nop 1
v_max_f32_dpp v38, v38, v38 quad_perm:[2,3,0,1] row_mask:0xf bank_mask:0xf
v_mov_b32 v6, v38
s_nop 1
v_permlane16_swap_b32 v38, v6
v_max_f32 v38, v38, v6
v_mov_b32 v6, v38
s_nop 1
v_permlane32_swap_b32 v38, v6
v_max_f32 v38, v38, v6
v_sub_f32 v32, v32, v38
v_sub_f32 v33, v33, v38
v_sub_f32 v34, v34, v38
v_sub_f32 v35, v35, v38
v_mul_f32 v32, 0x3fb8aa3b, v32
v_mul_f32 v33, 0x3fb8aa3b, v33
v_mul_f32 v34, 0x3fb8aa3b, v34
v_mul_f32 v35, 0x3fb8aa3b, v35
v_exp_f32 v32, v32
v_exp_f32 v33, v33
v_exp_f32 v34, v34
v_exp_f32 v35, v35
s_nop 0
v_add_f32 v39, v32, v33
v_add_f32 v39, v39, v34
v_add_f32 v39, v39, v35
v_cvt_pk_bf16_f32 v32, v32, v32
v_cvt_pk_bf16_f32 v33, v33, v33
v_cvt_pk_bf16_f32 v34, v34, v34
v_cvt_pk_bf16_f32 v35, v35, v35
s_nop 0
v_and_b32_dpp v40, v32, v4 quad_perm:[0,0,0,0] row_mask:0xf bank_mask:0xf
v_and_b32_dpp v41, v32, v5 quad_perm:[0,0,0,0] row_mask:0xf bank_mask:0xf
v_and_b32_dpp v42, v32, v4 quad_perm:[1,1,1,1] row_mask:0xf bank_mask:0xf
v_and_b32_dpp v43, v32, v5 quad_perm:[1,1,1,1] row_mask:0xf bank_mask:0xf
v_and_b32_dpp v44, v32, v4 quad_perm:[2,2,2,2] row_mask:0xf bank_mask:0xf
v_and_b32_dpp v45, v32, v5 quad_perm:[2,2,2,2] row_mask:0xf bank_mask:0xf
v_and_b32_dpp v46, v32, v4 quad_perm:[3,3,3,3] row_mask:0xf bank_mask:0xf
v_and_b32_dpp v47, v32, v5 quad_perm:[3,3,3,3] row_mask:0xf bank_mask:0xf
v_and_b32_dpp v48, v33, v4 quad_perm:[0,0,0,0] row_mask:0xf bank_mask:0xf
v_and_b32_dpp v49, v33, v5 quad_perm:[0,0,0,0] row_mask:0xf bank_mask:0xf
v_and_b32_dpp v50, v33, v4 quad_perm:[1,1,1,1] row_mask:0xf bank_mask:0xf
v_and_b32_dpp v51, v33, v5 quad_perm:[1,1,1,1] row_mask:0xf bank_mask:0xf
v_and_b32_dpp v52, v33, v4 quad_perm:[2,2,2,2] row_mask:0xf bank_mask:0xf
v_and_b32_dpp v53, v33, v5 quad_perm:[2,2,2,2] row_mask:0xf bank_mask:0xf
v_and_b32_dpp v54, v33, v4 quad_perm:[3,3,3,3] row_mask:0xf bank_mask:0xf
v_and_b32_dpp v55, v33, v5 quad_perm:[3,3,3,3] row_mask:0xf bank_mask:0xf
v_and_b32_dpp v56, v34, v4 quad_perm:[0,0,0,0] row_mask:0xf bank_mask:0xf
v_and_b32_dpp v57, v34, v5 quad_perm:[0,0,0,0] row_mask:0xf bank_mask:0xf
v_and_b32_dpp v58, v34, v4 quad_perm:[1,1,1,1] row_mask:0xf bank_mask:0xf
v_and_b32_dpp v59, v34, v5 quad_perm:[1,1,1,1] row_mask:0xf bank_mask:0xf
v_and_b32_dpp v60, v34, v4 quad_perm:[2,2,2,2] row_mask:0xf bank_mask:0xf
v_and_b32_dpp v61, v34, v5 quad_perm:[2,2,2,2] row_mask:0xf bank_mask:0xf
v_and_b32_dpp v62, v34, v4 quad_perm:[3,3,3,3] row_mask:0xf bank_mask:0xf
v_and_b32_dpp v63, v34, v5 quad_perm:[3,3,3,3] row_mask:0xf bank_mask:0xf
v_and_b32_dpp v64, v35, v4 quad_perm:[0,0,0,0] row_mask:0xf bank_mask:0xf
v_and_b32_dpp v65, v35, v5 quad_perm:[0,0,0,0] row_mask:0xf bank_mask:0xf
v_and_b32_dpp v66, v35, v4 quad_perm:[1,1,1,1] row_mask:0xf bank_mask:0xf
v_and_b32_dpp v67, v35, v5 quad_perm:[1,1,1,1] row_mask:0xf bank_mask:0xf
v_and_b32_dpp v68, v35, v4 quad_perm:[2,2,2,2] row_mask:0xf bank_mask:0xf
v_and_b32_dpp v69, v35, v5 quad_perm:[2,2,2,2] row_mask:0xf bank_mask:0xf
v_and_b32_dpp v70, v35, v4 quad_perm:[3,3,3,3] row_mask:0xf bank_mask:0xf
v_and_b32_dpp v71, v35, v5 quad_perm:[3,3,3,3] row_mask:0xf bank_mask:0xf
s_nop 1
v_add_f32_dpp v39, v39, v39 quad_perm:[1,0,3,2] row_mask:0xf bank_mask:0xf
s_nop 1
v_add_f32_dpp v39, v39, v39 quad_perm:[2,3,0,1] row_mask:0xf bank_mask:0xf
v_mov_b32 v6, v39
s_nop 1
v_permlane16_swap_b32 v39, v6
v_add_f32 v39, v39, v6
v_mov_b32 v6, v39
s_nop 1
v_permlane32_swap_b32 v39, v6
v_add_f32 v39, v39, v6
v_bfe_u32 v6, v0, 2, 2
v_lshlrev_b32 v6, 6, v6
s_lshl_b32 s57, s56, 3
v_add_u32 v6, s57, v6
s_mov_b64 exec, 0x1111
ds_write_b32 v6, v38 offset:40960
ds_write_b32 v6, v39 offset:40964
s_mov_b64 exec, -1
s_waitcnt vmcnt(15)
v_mfma_f32_16x16x16_bf16 v[72:75], v[104:105], v[40:41], 0
v_mfma_f32_16x16x16_bf16 v[76:79], v[106:107], v[40:41], 0
s_waitcnt vmcnt(14)
v_mfma_f32_16x16x16_bf16 v[80:83], v[108:109], v[42:43], 0
v_mfma_f32_16x16x16_bf16 v[84:87], v[110:111], v[42:43], 0
s_waitcnt vmcnt(13)
v_mfma_f32_16x16x16_bf16 v[72:75], v[112:113], v[44:45], v[72:75]
v_mfma_f32_16x16x16_bf16 v[76:79], v[114:115], v[44:45], v[76:79]
s_waitcnt vmcnt(12)
v_mfma_f32_16x16x16_bf16 v[80:83], v[116:117], v[46:47], v[80:83]
v_mfma_f32_16x16x16_bf16 v[84:87], v[118:119], v[46:47], v[84:87]
s_waitcnt vmcnt(11)
v_mfma_f32_16x16x16_bf16 v[72:75], v[120:121], v[48:49], v[72:75]
v_mfma_f32_16x16x16_bf16 v[76:79], v[122:123], v[48:49], v[76:79]
s_waitcnt vmcnt(10)
v_mfma_f32_16x16x16_bf16 v[80:83], v[124:125], v[50:51], v[80:83]
v_mfma_f32_16x16x16_bf16 v[84:87], v[126:127], v[50:51], v[84:87]
s_waitcnt vmcnt(9)
v_mfma_f32_16x16x16_bf16 v[72:75], v[128:129], v[52:53], v[72:75]
v_mfma_f32_16x16x16_bf16 v[76:79], v[130:131], v[52:53], v[76:79]
s_waitcnt vmcnt(8)
v_mfma_f32_16x16x16_bf16 v[80:83], v[132:133], v[54:55], v[80:83]
v_mfma_f32_16x16x16_bf16 v[84:87], v[134:135], v[54:55], v[84:87]
s_waitcnt vmcnt(7)
v_mfma_f32_16x16x16_bf16 v[72:75], v[136:137], v[56:57], v[72:75]
v_mfma_f32_16x16x16_bf16 v[76:79], v[138:139], v[56:57], v[76:79]
s_waitcnt vmcnt(6)
v_mfma_f32_16x16x16_bf16 v[80:83], v[140:141], v[58:59], v[80:83]
v_mfma_f32_16x16x16_bf16 v[84:87], v[142:143], v[58:59], v[84:87]
s_waitcnt vmcnt(5)
v_mfma_f32_16x16x16_bf16 v[72:75], v[144:145], v[60:61], v[72:75]
v_mfma_f32_16x16x16_bf16 v[76:79], v[146:147], v[60:61], v[76:79]
s_waitcnt vmcnt(4)
v_mfma_f32_16x16x16_bf16 v[80:83], v[148:149], v[62:63], v[80:83]
v_mfma_f32_16x16x16_bf16 v[84:87], v[150:151], v[62:63], v[84:87]
s_waitcnt vmcnt(3)
v_mfma_f32_16x16x16_bf16 v[72:75], v[152:153], v[64:65], v[72:75]
v_mfma_f32_16x16x16_bf16 v[76:79], v[154:155], v[64:65], v[76:79]
s_waitcnt vmcnt(2)
v_mfma_f32_16x16x16_bf16 v[80:83], v[156:157], v[66:67], v[80:83]
v_mfma_f32_16x16x16_bf16 v[84:87], v[158:159], v[66:67], v[84:87]
s_waitcnt vmcnt(1)
v_mfma_f32_16x16x16_bf16 v[72:75], v[160:161], v[68:69], v[72:75]
v_mfma_f32_16x16x16_bf16 v[76:79], v[162:163], v[68:69], v[76:79]
s_waitcnt vmcnt(0)
v_mfma_f32_16x16x16_bf16 v[80:83], v[164:165], v[70:71], v[80:83]
v_mfma_f32_16x16x16_bf16 v[84:87], v[166:167], v[70:71], v[84:87]
s_nop 7
v_add_f32 v72, v72, v80
v_add_f32 v73, v73, v81
v_add_f32 v74, v74, v82
v_add_f32 v75, v75, v83
v_add_f32 v76, v76, v84
v_add_f32 v77, v77, v85
v_add_f32 v78, v78, v86
v_add_f32 v79, v79, v87
s_lshl_b32 s57, s56, 11
v_lshlrev_b32 v6, 4, v0
v_add_u32 v6, s57, v6
ds_write_b128 v6, v[72:75] offset:24576
ds_write_b128 v6, v[76:79] offset:25600
s_waitcnt lgkmcnt(0)
v_mov_b32 v7, 41356
v_mov_b32 v8, 1
s_mov_b64 exec, 1
ds_add_u32 v7, v8
s_mov_b64 exec, -1
s_cmp_ge_u32 s56, 2
s_cbranch_scc1 L_end
s_branch L_kv_comb
L_kvp_n3:
v_add_u32 v1, s57, v6
v_add_u32 v2, s57, v8
buffer_load_dwordx4 v[40:43], v1, s[4:7], 0 offen offset:0 nt
buffer_load_dwordx4 v[44:47], v1, s[4:7], 0 offen offset:1024 nt
buffer_load_dwordx4 v[48:51], v1, s[4:7], 0 offen offset:2048 nt
buffer_load_dwordx4 v[52:55], v1, s[4:7], 0 offen offset:3072 nt
buffer_load_dwordx4 v[56:59], v1, s[4:7], s80 offen offset:0 nt
buffer_load_dwordx4 v[60:63], v1, s[4:7], s80 offen offset:1024 nt
buffer_load_dwordx4 v[64:67], v1, s[4:7], s80 offen offset:2048 nt
buffer_load_dwordx4 v[68:71], v1, s[4:7], s80 offen offset:3072 nt
buffer_load_dwordx4 v[72:75], v1, s[4:7], s81 offen offset:0 nt
buffer_load_dwordx4 v[76:79], v1, s[4:7], s81 offen offset:1024 nt
buffer_load_dwordx4 v[80:83], v1, s[4:7], s81 offen offset:2048 nt
buffer_load_dwordx4 v[84:87], v1, s[4:7], s81 offen offset:3072 nt
buffer_load_dwordx4 v[104:107], v2, s[8:11], 0 offen offset:0 nt
buffer_load_dwordx4 v[108:111], v2, s[8:11], 0 offen offset:1024 nt
buffer_load_dwordx4 v[112:115], v2, s[8:11], 0 offen offset:2048 nt
buffer_load_dwordx4 v[116:119], v2, s[8:11], 0 offen offset:3072 nt
buffer_load_dwordx4 v[120:123], v2, s[8:11], s80 offen offset:0 nt
buffer_load_dwordx4 v[124:127], v2, s[8:11], s80 offen offset:1024 nt
buffer_load_dwordx4 v[128:131], v2, s[8:11], s80 offen offset:2048 nt
buffer_load_dwordx4 v[132:135], v2, s[8:11], s80 offen offset:3072 nt
buffer_load_dwordx4 v[136:139], v2, s[8:11], s81 offen offset:0 nt
buffer_load_dwordx4 v[140:143], v2, s[8:11], s81 offen offset:1024 nt
buffer_load_dwordx4 v[144:147], v2, s[8:11], s81 offen offset:2048 nt
buffer_load_dwordx4 v[148:151], v2, s[8:11], s81 offen offset:3072 nt
s_barrier
L_kvall_113:
v_mov_b32 v6, 0xffff
v_mov_b32 v4, s91
v_cndmask_b32 v4, v6, v4, s[60:61]
v_mov_b32 v6, 0
v_cndmask_b32 v5, v6, v4, s[62:63]
v_cndmask_b32 v4, v4, v6, s[62:63]
s_waitcnt lgkmcnt(0)
s_add_u32 s59, s59, 1
s_and_b32 s53, s59, 0xffff
s_and_b32 s94, s59, 15
v_mov_b32 v3, s53
v_mov_b32 v6, 41352
s_mov_b32 s55, 0
L_lw_114:
ds_read_b32 v7, v6
s_waitcnt lgkmcnt(0)
v_readfirstlane_b32 s57, v7
s_add_u32 s55, s55, 1
s_cmp_ge_u32 s57, 4
s_cbranch_scc1 L_lwd_115
s_sleep 1
s_cmp_lt_u32 s55, 400000
s_cbranch_scc1 L_lw_114
L_lwd_115:
v_bfe_u32 v6, v0, 2, 2
v_lshlrev_b32 v6, 8, v6
v_lshrrev_b32 v7, 4, v0
v_lshl_add_u32 v6, v7, 6, v6
v_and_b32 v7, 3, v0
v_lshl_add_u32 v6, v7, 4, v6
ds_read_b128 v[12:15], v6 offset:20480
s_waitcnt lgkmcnt(0)
s_waitcnt vmcnt(20)
v_mfma_f32_16x16x32_bf16 v[16:19], v[40:43], v[12:15], 0
v_mfma_f32_16x16x32_bf16 v[20:23], v[44:47], v[12:15], 0
v_mfma_f32_16x16x32_bf16 v[24:27], v[48:51], v[12:15], 0
v_mfma_f32_16x16x32_bf16 v[28:31], v[52:55], v[12:15], 0
s_nop 7
v_cndmask_b32 v16, v16, v17, s[60:61]
v_cndmask_b32 v18, v18, v19, s[60:61]
v_cndmask_b32 v16, v16, v18, s[62:63]
v_cndmask_b32 v20, v20, v21, s[60:61]
v_cndmask_b32 v22, v22, v23, s[60:61]
v_cndmask_b32 v20, v20, v22, s[62:63]
v_cndmask_b32 v24, v24, v25, s[60:61]
v_cndmask_b32 v26, v26, v27, s[60:61]
v_cndmask_b32 v24, v24, v26, s[62:63]
v_cndmask_b32 v28, v28, v29, s[60:61]
v_cndmask_b32 v30, v30, v31, s[60:61]
v_cndmask_b32 v28, v28, v30, s[62:63]
v_cndmask_b32 v17, v16, v20, s[60:61]
v_cndmask_b32 v18, v20, v16, s[60:61]
v_cndmask_b32 v25, v24, v28, s[60:61]
v_cndmask_b32 v26, v28, v24, s[60:61]
s_nop 0
v_add_f32_dpp v16, v18, v17 quad_perm:[1,0,3,2] row_mask:0xf bank_mask:0xf
v_add_f32_dpp v24, v26, v25 quad_perm:[1,0,3,2] row_mask:0xf bank_mask:0xf
v_cndmask_b32 v17, v16, v24, s[62:63]
v_cndmask_b32 v18, v24, v16, s[62:63]
s_nop 1
v_add_f32_dpp v32, v18, v17 quad_perm:[2,3,0,1] row_mask:0xf bank_mask:0xf
s_waitcnt vmcnt(16)
v_mfma_f32_16x16x32_bf16 v[16:19], v[56:59], v[12:15], 0
v_mfma_f32_16x16x32_bf16 v[20:23], v[60:63], v[12:15], 0
v_mfma_f32_16x16x32_bf16 v[24:27], v[64:67], v[12:15], 0
v_mfma_f32_16x16x32_bf16 v[28:31], v[68:71], v[12:15], 0
s_nop 7
v_cndmask_b32 v16, v16, v17, s[60:61]
v_cndmask_b32 v18, v18, v19, s[60:61]
v_cndmask_b32 v16, v16, v18, s[62:63]
v_cndmask_b32 v20, v20, v21, s[60:61]
v_cndmask_b32 v22, v22, v23, s[60:61]
v_cndmask_b32 v20, v20, v22, s[62:63]
v_cndmask_b32 v24, v24, v25, s[60:61]
v_cndmask_b32 v26, v26, v27, s[60:61]
v_cndmask_b32 v24, v24, v26, s[62:63]
v_cndmask_b32 v28, v28, v29, s[60:61]
v_cndmask_b32 v30, v30, v31, s[60:61]
v_cndmask_b32 v28, v28, v30, s[62:63]
v_cndmask_b32 v17, v16, v20, s[60:61]
v_cndmask_b32 v18, v20, v16, s[60:61]
v_cndmask_b32 v25, v24, v28, s[60:61]
v_cndmask_b32 v26, v28, v24, s[60:61]
s_nop 0
v_add_f32_dpp v16, v18, v17 quad_perm:[1,0,3,2] row_mask:0xf bank_mask:0xf
v_add_f32_dpp v24, v26, v25 quad_perm:[1,0,3,2] row_mask:0xf bank_mask:0xf
v_cndmask_b32 v17, v16, v24, s[62:63]
v_cndmask_b32 v18, v24, v16, s[62:63]
s_nop 1
v_add_f32_dpp v33, v18, v17 quad_perm:[2,3,0,1] row_mask:0xf bank_mask:0xf
s_waitcnt vmcnt(12)
v_mfma_f32_16x16x32_bf16 v[16:19], v[72:75], v[12:15], 0
v_mfma_f32_16x16x32_bf16 v[20:23], v[76:79], v[12:15], 0
v_mfma_f32_16x16x32_bf16 v[24:27], v[80:83], v[12:15], 0
v_mfma_f32_16x16x32_bf16 v[28:31], v[84:87], v[12:15], 0
s_nop 7
v_cndmask_b32 v16, v16, v17, s[60:61]
v_cndmask_b32 v18, v18, v19, s[60:61]
v_cndmask_b32 v16, v16, v18, s[62:63]
v_cndmask_b32 v20, v20, v21, s[60:61]
v_cndmask_b32 v22, v22, v23, s[60:61]
v_cndmask_b32 v20, v20, v22, s[62:63]
v_cndmask_b32 v24, v24, v25, s[60:61]
v_cndmask_b32 v26, v26, v27, s[60:61]
v_cndmask_b32 v24, v24, v26, s[62:63]
v_cndmask_b32 v28, v28, v29, s[60:61]
v_cndmask_b32 v30, v30, v31, s[60:61]
v_cndmask_b32 v28, v28, v30, s[62:63]
v_cndmask_b32 v17, v16, v20, s[60:61]
v_cndmask_b32 v18, v20, v16, s[60:61]
v_cndmask_b32 v25, v24, v28, s[60:61]
v_cndmask_b32 v26, v28, v24, s[60:61]
s_nop 0
v_add_f32_dpp v16, v18, v17 quad_perm:[1,0,3,2] row_mask:0xf bank_mask:0xf
v_add_f32_dpp v24, v26, v25 quad_perm:[1,0,3,2] row_mask:0xf bank_mask:0xf
v_cndmask_b32 v17, v16, v24, s[62:63]
v_cndmask_b32 v18, v24, v16, s[62:63]
s_nop 1
v_add_f32_dpp v34, v18, v17 quad_perm:[2,3,0,1] row_mask:0xf bank_mask:0xf
v_cvt_pk_bf16_f32 v6, v32, v33
v_lshlrev_b32 v32, 16, v6
v_and_b32 v33, s91, v6
v_cvt_pk_bf16_f32 v34, v34, v34
v_and_b32 v34, s91, v34
v_mul_f32 v32, 0x3db504f3, v32
v_mul_f32 v33, 0x3db504f3, v33
v_mul_f32 v34, 0x3db504f3, v34
v_cvt_pk_bf16_f32 v6, v32, v33
v_lshlrev_b32 v32, 16, v6
v_and_b32 v33, s91, v6
v_cvt_pk_bf16_f32 v34, v34, v34
v_and_b32 v34, s91, v34
v_max3_f32 v38, v32, v33, v34
s_nop 1
v_max_f32_dpp v38, v38, v38 quad_perm:[1,0,3,2] row_mask:0xf bank_mask:0xf
s_nop 1
v_max_f32_dpp v38, v38, v38 quad_perm:[2,3,0,1] row_mask:0xf bank_mask:0xf
v_mov_b32 v6, v38
s_nop 1
v_permlane16_swap_b32 v38, v6
v_max_f32 v38, v38, v6
v_mov_b32 v6, v38
s_nop 1
v_permlane32_swap_b32 v38, v6
v_max_f32 v38, v38, v6
v_sub_f32 v32, v32, v38
v_sub_f32 v33, v33, v38
v_sub_f32 v34, v34, v38
v_mul_f32 v32, 0x3fb8aa3b, v32
v_mul_f32 v33, 0x3fb8aa3b, v33
v_mul_f32 v34, 0x3fb8aa3b, v34
v_exp_f32 v32, v32
v_exp_f32 v33, v33
v_exp_f32 v34, v34
s_nop 0
v_add_f32 v39, v32, v33
v_add_f32 v39, v39, v34
v_cvt_pk_bf16_f32 v32, v32, v32
v_cvt_pk_bf16_f32 v33, v33, v33
v_cvt_pk_bf16_f32 v34, v34, v34
s_nop 0
v_and_b32_dpp v40, v32, v4 quad_perm:[0,0,0,0] row_mask:0xf bank_mask:0xf
v_and_b32_dpp v41, v32, v5 quad_perm:[0,0,0,0] row_mask:0xf bank_mask:0xf
v_and_b32_dpp v42, v32, v4 quad_perm:[1,1,1,1] row_mask:0xf bank_mask:0xf
v_and_b32_dpp v43, v32, v5 quad_perm:[1,1,1,1] row_mask:0xf bank_mask:0xf
v_and_b32_dpp v44, v32, v4 quad_perm:[2,2,2,2] row_mask:0xf bank_mask:0xf
v_and_b32_dpp v45, v32, v5 quad_perm:[2,2,2,2] row_mask:0xf bank_mask:0xf
v_and_b32_dpp v46, v32, v4 quad_perm:[3,3,3,3] row_mask:0xf bank_mask:0xf
v_and_b32_dpp v47, v32, v5 quad_perm:[3,3,3,3] row_mask:0xf bank_mask:0xf
v_and_b32_dpp v48, v33, v4 quad_perm:[0,0,0,0] row_mask:0xf bank_mask:0xf
v_and_b32_dpp v49, v33, v5 quad_perm:[0,0,0,0] row_mask:0xf bank_mask:0xf
v_and_b32_dpp v50, v33, v4 quad_perm:[1,1,1,1] row_mask:0xf bank_mask:0xf
v_and_b32_dpp v51, v33, v5 quad_perm:[1,1,1,1] row_mask:0xf bank_mask:0xf
v_and_b32_dpp v52, v33, v4 quad_perm:[2,2,2,2] row_mask:0xf bank_mask:0xf
v_and_b32_dpp v53, v33, v5 quad_perm:[2,2,2,2] row_mask:0xf bank_mask:0xf
v_and_b32_dpp v54, v33, v4 quad_perm:[3,3,3,3] row_mask:0xf bank_mask:0xf
v_and_b32_dpp v55, v33, v5 quad_perm:[3,3,3,3] row_mask:0xf bank_mask:0xf
v_and_b32_dpp v56, v34, v4 quad_perm:[0,0,0,0] row_mask:0xf bank_mask:0xf
v_and_b32_dpp v57, v34, v5 quad_perm:[0,0,0,0] row_mask:0xf bank_mask:0xf
v_and_b32_dpp v58, v34, v4 quad_perm:[1,1,1,1] row_mask:0xf bank_mask:0xf
v_and_b32_dpp v59, v34, v5 quad_perm:[1,1,1,1] row_mask:0xf bank_mask:0xf
v_and_b32_dpp v60, v34, v4 quad_perm:[2,2,2,2] row_mask:0xf bank_mask:0xf
v_and_b32_dpp v61, v34, v5 quad_perm:[2,2,2,2] row_mask:0xf bank_mask:0xf
v_and_b32_dpp v62, v34, v4 quad_perm:[3,3,3,3] row_mask:0xf bank_mask:0xf
v_and_b32_dpp v63, v34, v5 quad_perm:[3,3,3,3] row_mask:0xf bank_mask:0xf
s_nop 1
v_add_f32_dpp v39, v39, v39 quad_perm:[1,0,3,2] row_mask:0xf bank_mask:0xf
s_nop 1
v_add_f32_dpp v39, v39, v39 quad_perm:[2,3,0,1] row_mask:0xf bank_mask:0xf
v_mov_b32 v6, v39
s_nop 1
v_permlane16_swap_b32 v39, v6
v_add_f32 v39, v39, v6
v_mov_b32 v6, v39
s_nop 1
v_permlane32_swap_b32 v39, v6
v_add_f32 v39, v39, v6
v_bfe_u32 v6, v0, 2, 2
v_lshlrev_b32 v6, 6, v6
s_lshl_b32 s57, s56, 3
v_add_u32 v6, s57, v6
s_mov_b64 exec, 0x1111
ds_write_b32 v6, v38 offset:40960
ds_write_b32 v6, v39 offset:40964
s_mov_b64 exec, -1
s_waitcnt vmcnt(11)
v_mfma_f32_16x16x16_bf16 v[72:75], v[104:105], v[40:41], 0
v_mfma_f32_16x16x16_bf16 v[76:79], v[106:107], v[40:41], 0
s_waitcnt vmcnt(10)
v_mfma_f32_16x16x16_bf16 v[80:83], v[108:109], v[42:43], 0
v_mfma_f32_16x16x16_bf16 v[84:87], v[110:111], v[42:43], 0
s_waitcnt vmcnt(9)
v_mfma_f32_16x16x16_bf16 v[72:75], v[112:113], v[44:45], v[72:75]
v_mfma_f32_16x16x16_bf16 v[76:79], v[114:115], v[44:45], v[76:79]
s_waitcnt vmcnt(8)
v_mfma_f32_16x16x16_bf16 v[80:83], v[116:117], v[46:47], v[80:83]
v_mfma_f32_16x16x16_bf16 v[84:87], v[118:119], v[46:47], v[84:87]
s_waitcnt vmcnt(7)
v_mfma_f32_16x16x16_bf16 v[72:75], v[120:121], v[48:49], v[72:75]
v_mfma_f32_16x16x16_bf16 v[76:79], v[122:123], v[48:49], v[76:79]
s_waitcnt vmcnt(6)
v_mfma_f32_16x16x16_bf16 v[80:83], v[124:125], v[50:51], v[80:83]
v_mfma_f32_16x16x16_bf16 v[84:87], v[126:127], v[50:51], v[84:87]
s_waitcnt vmcnt(5)
v_mfma_f32_16x16x16_bf16 v[72:75], v[128:129], v[52:53], v[72:75]
v_mfma_f32_16x16x16_bf16 v[76:79], v[130:131], v[52:53], v[76:79]
s_waitcnt vmcnt(4)
v_mfma_f32_16x16x16_bf16 v[80:83], v[132:133], v[54:55], v[80:83]
v_mfma_f32_16x16x16_bf16 v[84:87], v[134:135], v[54:55], v[84:87]
s_waitcnt vmcnt(3)
v_mfma_f32_16x16x16_bf16 v[72:75], v[136:137], v[56:57], v[72:75]
v_mfma_f32_16x16x16_bf16 v[76:79], v[138:139], v[56:57], v[76:79]
s_waitcnt vmcnt(2)
v_mfma_f32_16x16x16_bf16 v[80:83], v[140:141], v[58:59], v[80:83]
v_mfma_f32_16x16x16_bf16 v[84:87], v[142:143], v[58:59], v[84:87]
s_waitcnt vmcnt(1)
v_mfma_f32_16x16x16_bf16 v[72:75], v[144:145], v[60:61], v[72:75]
v_mfma_f32_16x16x16_bf16 v[76:79], v[146:147], v[60:61], v[76:79]
s_waitcnt vmcnt(0)
v_mfma_f32_16x16x16_bf16 v[80:83], v[148:149], v[62:63], v[80:83]
v_mfma_f32_16x16x16_bf16 v[84:87], v[150:151], v[62:63], v[84:87]
s_nop 7
v_add_f32 v72, v72, v80
v_add_f32 v73, v73, v81
v_add_f32 v74, v74, v82
v_add_f32 v75, v75, v83
v_add_f32 v76, v76, v84
v_add_f32 v77, v77, v85
v_add_f32 v78, v78, v86
v_add_f32 v79, v79, v87
s_lshl_b32 s57, s56, 11
v_lshlrev_b32 v6, 4, v0
v_add_u32 v6, s57, v6
ds_write_b128 v6, v[72:75] offset:24576
ds_write_b128 v6, v[76:79] offset:25600
s_waitcnt lgkmcnt(0)
v_mov_b32 v7, 41356
v_mov_b32 v8, 1
s_mov_b64 exec, 1
ds_add_u32 v7, v8
s_mov_b64 exec, -1
s_cmp_ge_u32 s56, 2
s_cbranch_scc1 L_end
L_kv_comb:
v_mov_b32 v6, 41356
s_mov_b32 s55, 0
L_lw_116:
ds_read_b32 v7, v6
s_waitcnt lgkmcnt(0)
v_readfirstlane_b32 s57, v7
s_add_u32 s55, s55, 1
s_cmp_ge_u32 s57, 8
s_cbranch_scc1 L_lwd_117
s_cmp_lt_u32 s55, 400000
s_cbranch_scc1 L_lw_116
L_lwd_117:
s_lshl_b32 s57, s56, 10
v_lshlrev_b32 v6, 4, v0
v_add_u32 v6, s57, v6
v_bfe_u32 v7, v0, 2, 2
v_lshlrev_b32 v7, 6, v7
ds_read_b128 v[136:139], v7 offset:40960
ds_read_b128 v[140:143], v7 offset:40976
ds_read_b128 v[144:147], v7 offset:40992
ds_read_b128 v[148:151], v7 offset:41008
ds_read_b128 v[104:107], v6 offset:24576
ds_read_b128 v[108:111], v6 offset:26624
ds_read_b128 v[112:115], v6 offset:28672
ds_read_b128 v[116:119], v6 offset:30720
ds_read_b128 v[120:123], v6 offset:32768
ds_read_b128 v[124:127], v6 offset:34816
ds_read_b128 v[128:131], v6 offset:36864
ds_read_b128 v[132:135], v6 offset:38912
s_waitcnt lgkmcnt(8)
v_max3_f32 v38, v136, v138, v140
v_max3_f32 v38, v38, v142, v144
v_max3_f32 v38, v38, v146, v148
v_max_f32 v38, v38, v150
v_sub_f32 v136, v136, v38
v_sub_f32 v138, v138, v38
v_sub_f32 v140, v140, v38
v_sub_f32 v142, v142, v38
v_sub_f32 v144, v144, v38
v_sub_f32 v146, v146, v38
v_sub_f32 v148, v148, v38
v_sub_f32 v150, v150, v38
v_mul_f32 v136, 0x3fb8aa3b, v136
v_mul_f32 v138, 0x3fb8aa3b, v138
v_mul_f32 v140, 0x3fb8aa3b, v140
v_mul_f32 v142, 0x3fb8aa3b, v142
v_mul_f32 v144, 0x3fb8aa3b, v144
v_mul_f32 v146, 0x3fb8aa3b, v146
v_mul_f32 v148, 0x3fb8aa3b, v148
v_mul_f32 v150, 0x3fb8aa3b, v150
v_exp_f32 v136, v136
v_exp_f32 v138, v138
v_exp_f32 v140, v140
v_exp_f32 v142, v142
v_exp_f32 v144, v144
v_exp_f32 v146, v146
v_exp_f32 v148, v148
v_exp_f32 v150, v150
s_nop 0
v_mul_f32 v39, v136, v137
v_fmac_f32 v39, v138, v139
v_fmac_f32 v39, v140, v141
v_fmac_f32 v39, v142, v143
v_fmac_f32 v39, v144, v145
v_fmac_f32 v39, v146, v147
v_fmac_f32 v39, v148, v149
v_fmac_f32 v39, v150, v151
s_waitcnt lgkmcnt(0)
v_mul_f32 v152, v136, v104
v_mul_f32 v153, v136, v105
v_mul_f32 v154, v136, v106
v_mul_f32 v155, v136, v107
v_fmac_f32 v152, v138, v108
v_fmac_f32 v153, v138, v109
v_fmac_f32 v154, v138, v110
v_fmac_f32 v155, v138, v111
v_fmac_f32 v152, v140, v112
v_fmac_f32 v153, v140, v113
v_fmac_f32 v154, v140, v114
v_fmac_f32 v155, v140, v115
v_fmac_f32 v152, v142, v116
v_fmac_f32 v153, v142, v117
v_fmac_f32 v154, v142, v118
v_fmac_f32 v155, v142, v119
v_fmac_f32 v152, v144, v120
v_fmac_f32 v153, v144, v121
v_fmac_f32 v154, v144, v122
v_fmac_f32 v155, v144, v123
v_fmac_f32 v152, v146, v124
v_fmac_f32 v153, v146, v125
v_fmac_f32 v154, v146, v126
v_fmac_f32 v155, v146, v127
v_fmac_f32 v152, v148, v128
v_fmac_f32 v153, v148, v129
v_fmac_f32 v154, v148, v130
v_fmac_f32 v155, v148, v131
v_fmac_f32 v152, v150, v132
v_fmac_f32 v153, v150, v133
v_fmac_f32 v154, v150, v134
v_fmac_f32 v155, v150, v135
v_and_or_b32 v152, v152, -16, s94
v_and_or_b32 v153, v153, -16, s94
v_and_or_b32 v154, v154, -16, s94
v_and_or_b32 v155, v155, -16, s94
s_lshl_b32 s57, s84, 3
s_add_u32 s57, s57, s85
s_lshl_b32 s57, s57, 11
s_add_u32 s57, s57, 1048576
buffer_store_dwordx4 v[152:155], v6, s[12:15], s57 offen sc1
s_cmp_lg_u32 s56, 0
s_cbranch_scc1 L_kv_sig
v_or_b32 v156, v38, v3
v_and_or_b32 v157, v39, s91, v3
v_lshl_or_b32 v158, v39, 16, v3
v_mov_b32 v159, v3
v_lshlrev_b32 v7, 1, v7
s_lshl_b32 s57, s84, 9
s_lshl_b32 s58, s85, 4
s_add_u32 s57, s57, s58
s_add_u32 s57, s57, 1572864
s_mov_b64 exec, 0x1111
buffer_store_dwordx4 v[156:159], v7, s[12:15], s57 offen sc1
s_mov_b64 exec, -1
L_kv_sig:
v_mov_b32 v7, 41364
v_mov_b32 v8, 1
s_mov_b64 exec, 1
ds_add_u32 v7, v8
s_waitcnt lgkmcnt(0)
s_endpgm
L_end:
s_endpgm
.section .rodata,"a"
.p2align 6
.amdhsa_kernel adaLN_cond__gqa_block_cached__swiglu_ffn__decode_kernel
  .amdhsa_next_free_vgpr 168
  .amdhsa_next_free_sgpr 102
  .amdhsa_accum_offset 168
  .amdhsa_group_segment_fixed_size 0
  .amdhsa_kernarg_size 112
  .amdhsa_user_sgpr_count 2
  .amdhsa_user_sgpr_kernarg_segment_ptr 1
  .amdhsa_system_sgpr_workgroup_id_x 1
.end_amdhsa_kernel
```
